```python
import torch

def _softmax(x, axis=-1):
    return torch.softmax(x, dim=axis)
def _gelu(x):
    return torch.nn.functional.gelu(x, approximate="tanh")
def _silu(x):
    return torch.nn.functional.silu(x)
def _sigmoid(x):
    return torch.sigmoid(x)
def _layernorm(x, axis=-1, eps=1e-5):
    m = x.mean(dim=axis, keepdim=True)
    v = x.var(dim=axis, keepdim=True, unbiased=False)
    return (x - m) / torch.sqrt(v + eps)
def _scatter_add(tgt, idx, src, axis=0):
    return tgt.clone().index_add_(axis, idx, src)
def _segment_sum(src, seg, n):
    out = torch.zeros((n,) + src.shape[1:], dtype=src.dtype)
    return out.index_add_(0, seg, src)
def _pad(x, pw):
    flat = tuple(v for pair in reversed(pw) for v in pair)
    return torch.nn.functional.pad(x, flat)

kernel_name = 'standalone__detection_seg_fpn_lateral__vision'

def setup_inputs():

    _w = (lambda a: (lambda t: t.to(torch.bfloat16) if t.is_floating_point() else t)(torch.as_tensor(a)))
    H = W = (224 // 2) * 2
    C = 192
    k = 3
    return {
        "c_fine": _w((lambda *s: torch.randn(*s, dtype=torch.bfloat16) * 0.05)(1, H, W, C)),
        "p_coarse": _w((lambda *s: torch.randn(*s, dtype=torch.bfloat16) * 0.05)(1, H // 2, W // 2, C)),
        "w_lat": _w((lambda *s: torch.randn(*s, dtype=torch.bfloat16) * 0.05)(C, C)),
        "w_out": _w((lambda *s: torch.randn(*s, dtype=torch.bfloat16) * 0.05)(k, k, C, C)),
    }

def reference(c_fine, p_coarse, w_lat, w_out):
    B, H, W, C = c_fine.shape
    k = 3
    lat = torch.einsum("bhwc,cd->bhwd", c_fine, w_lat)
    up = (lambda x, n, axis: torch.repeat_interleave(x, n, dim=axis))((lambda x, n, axis: torch.repeat_interleave(x, n, dim=axis))(p_coarse, 2, axis=1), 2, axis=2)
    m = lat + up
    pad = k // 2
    mp = _pad(m, ((0, 0), (pad, pad), (pad, pad), (0, 0)))
    o = None
    for di in range(k):
        for dj in range(k):
            t = torch.einsum("bhwc,cd->bhwd", mp[:, di:di + H, dj:dj + W, :], w_out[di, dj])
            o = t if o is None else o + t
    return o
```

```asm
; @launch grid=(256,1,1) block=(256,1,1) lds=161408
.amdgcn_target "amdgcn-amd-amdhsa--gfx950"
.text
.globl standalone__detection_seg_fpn_lateral__vision_kernel
.p2align 8
.type standalone__detection_seg_fpn_lateral__vision_kernel,@function
standalone__detection_seg_fpn_lateral__vision_kernel:
s_cmp_ge_u32 s2, 256
s_cbranch_scc1 Lend
s_load_dwordx8 s[4:11], s[0:1], 0
s_load_dwordx4 s[12:15], s[0:1], 32
s_load_dwordx2 s[16:17], s[0:1], 48
s_and_b32 s52, s2, 7
s_lshr_b32 s53, s2, 3
s_lshr_b32 s54, s52, 1
s_lshl_b32 s54, s54, 2
s_lshr_b32 s55, s53, 3
s_add_u32 s54, s54, s55
s_mul_i32 s49, s54, 14
s_and_b32 s54, s52, 1
s_lshl_b32 s54, s54, 3
s_and_b32 s55, s53, 7
s_add_u32 s54, s54, s55
s_mul_i32 s50, s54, 14
v_lshrrev_b32 v208, 6, v0
v_and_b32 v1, 63, v0
v_readfirstlane_b32 s48, v208
v_and_b32 v2, 15, v1
v_lshrrev_b32 v3, 4, v1
v_and_b32 v208, 1, v3
v_lshlrev_b32 v208, 5, v208
v_lshrrev_b32 v209, 1, v3
v_lshl_add_u32 v5, v209, 4, v208
v_mov_b32 v212, 1073741824
v_lshlrev_b32 v13, 4, v1
s_lshl_b32 s52, s48, 6
s_lshl_b32 s57, s48, 5
s_add_u32 s57, s57, 256
s_mul_i32 s55, s48, 6624
s_mul_i32 s3, s48, 3072
s_lshl_b32 s53, s2, 2
s_add_u32 s53, s53, s48
s_mul_i32 s54, s53, 5462
s_lshr_b32 s54, s54, 16
s_mul_i32 s73, s54, 12
s_sub_u32 s73, s53, s73
s_lshl_b32 s51, s53, 10
s_mul_i32 s54, s54, 12288
s_mul_i32 s53, s73, 86
s_lshr_b32 s53, s53, 8
s_mul_i32 s58, s53, 3
s_sub_u32 s73, s73, s58
s_lshl_b32 s58, s73, 3
s_lshl_b32 s59, s53, 6
s_add_u32 s58, s58, s59
s_lshl_b32 s59, s53, 5
s_add_u32 s59, s59, 256
s_cmp_lt_u32 s73, 2
s_cselect_b32 s58, s58, s59
s_cselect_b32 s53, 16, 8
s_add_u32 s54, s54, s58
s_cmp_lt_u32 s2, 54
s_cselect_b32 s54, s54, 1073741824
s_cselect_b32 s51, s51, 1073741824
s_cselect_b32 s59, 0, 1073741824
v_lshrrev_b32 v210, 2, v2
v_lshrrev_b32 v211, 1, v5
v_add_u32 v211, v211, v210
v_mul_u32_u24 v211, 384, v211
v_and_b32 v209, 3, v1
v_mul_u32_u24 v208, s53, v209
v_add3_u32 v29, v211, v208, s54
v_add_u32 v15, s51, v13
v_lshrrev_b32 v210, 1, v210
v_lshlrev_b32 v210, 6, v210
v_lshlrev_b32 v208, 4, v209
v_add3_u32 v243, v208, s52, 0
v_xor_b32 v243, v243, v210
v_add_u32 v243, v243, v211
v_add_u32 v243, 52992, v243
v_lshlrev_b32 v208, 4, v209
v_add3_u32 v244, v208, s52, 8
v_xor_b32 v244, v244, v210
v_add_u32 v244, v244, v211
v_add_u32 v244, 52992, v244
v_lshlrev_b32 v208, 3, v209
v_add3_u32 v245, v208, s57, 0
v_xor_b32 v245, v245, v210
v_add_u32 v245, v245, v211
v_add_u32 v245, 52992, v245
v_add_u32 v208, 0, v1
v_mul_u32_u24 v209, 2731, v208
v_lshrrev_b32 v209, 17, v209
v_and_b32 v209, 1, v209
v_lshlrev_b32 v209, 2, v209
v_xor_b32 v209, v1, v209
v_lshlrev_b32 v240, 4, v209
v_add_u32 v208, 64, v1
v_mul_u32_u24 v209, 2731, v208
v_lshrrev_b32 v209, 17, v209
v_and_b32 v209, 1, v209
v_lshlrev_b32 v209, 2, v209
v_xor_b32 v209, v1, v209
v_lshlrev_b32 v241, 4, v209
v_add_u32 v208, 128, v1
v_mul_u32_u24 v209, 2731, v208
v_lshrrev_b32 v209, 17, v209
v_and_b32 v209, 1, v209
v_lshlrev_b32 v209, 2, v209
v_xor_b32 v209, v1, v209
v_lshlrev_b32 v242, 4, v209
s_waitcnt lgkmcnt(0)
s_mov_b32 s32, s10
s_mov_b32 s33, s11
s_mov_b32 s34, 663552
s_mov_b32 s35, 0x00020000
s_mov_b32 s28, s8
s_mov_b32 s29, s9
s_mov_b32 s30, 73728
s_mov_b32 s31, 0x00020000
s_mov_b32 s20, s4
s_mov_b32 s21, s5
s_mov_b32 s22, 19267584
s_mov_b32 s23, 0x00020000
s_mov_b32 s58, 0
buffer_load_dwordx2 v[86:87], v29, s[32:35], s58 offen
buffer_load_dwordx2 v[88:89], v29, s[32:35], s58 offen offset:1536
s_mov_b32 s58, 221184
buffer_load_dwordx2 v[90:91], v29, s[32:35], s58 offen
buffer_load_dwordx2 v[92:93], v29, s[32:35], s58 offen offset:1536
s_mov_b32 s58, 442368
buffer_load_dwordx2 v[94:95], v29, s[32:35], s58 offen
buffer_load_dwordx2 v[96:97], v29, s[32:35], s58 offen offset:1536
s_add_u32 m0, s3, 52992
s_add_u32 s58, s3, 0
buffer_load_dwordx4 v240, s[28:31], s58 offen lds
buffer_load_dwordx4 v241, s[28:31], s58 offen offset:1024 lds
buffer_load_dwordx4 v242, s[28:31], s58 offen offset:2048 lds
s_add_u32 m0, s3, 65280
s_add_u32 s58, s3, 12288
buffer_load_dwordx4 v240, s[28:31], s58 offen lds
buffer_load_dwordx4 v241, s[28:31], s58 offen offset:1024 lds
buffer_load_dwordx4 v242, s[28:31], s58 offen offset:2048 lds
s_add_u32 m0, s3, 77568
s_add_u32 s58, s3, 24576
buffer_load_dwordx4 v240, s[28:31], s58 offen lds
buffer_load_dwordx4 v241, s[28:31], s58 offen offset:1024 lds
buffer_load_dwordx4 v242, s[28:31], s58 offen offset:2048 lds
s_add_u32 m0, s3, 89856
s_add_u32 s58, s3, 36864
buffer_load_dwordx4 v240, s[28:31], s58 offen lds
buffer_load_dwordx4 v241, s[28:31], s58 offen offset:1024 lds
buffer_load_dwordx4 v242, s[28:31], s58 offen offset:2048 lds
s_add_u32 m0, s3, 102144
s_add_u32 s58, s3, 49152
buffer_load_dwordx4 v240, s[28:31], s58 offen lds
buffer_load_dwordx4 v241, s[28:31], s58 offen offset:1024 lds
buffer_load_dwordx4 v242, s[28:31], s58 offen offset:2048 lds
s_add_u32 m0, s3, 114432
s_add_u32 s58, s3, 61440
buffer_load_dwordx4 v240, s[28:31], s58 offen lds
buffer_load_dwordx4 v241, s[28:31], s58 offen offset:1024 lds
buffer_load_dwordx4 v242, s[28:31], s58 offen offset:2048 lds
s_sub_u32 s54, s50, 1
v_add_u32 v208, 0, v1
v_mul_u32_u24 v209, 2622, v208
v_lshrrev_b32 v209, 16, v209
v_mul_u32_u24 v210, 25, v209
v_sub_u32 v210, v208, v210
v_add_u32 v209, s54, v209
v_cmp_gt_u32 vcc, 224, v209
v_cmp_gt_u32 s[18:19], 24, v210
v_mul_u32_u24 v211, 384, v209
v_lshl_add_u32 v211, v210, 4, v211
v_cndmask_b32 v211, v212, v211, vcc
v_cndmask_b32 v6, v212, v211, s[18:19]
v_add_u32 v208, 64, v1
v_mul_u32_u24 v209, 2622, v208
v_lshrrev_b32 v209, 16, v209
v_mul_u32_u24 v210, 25, v209
v_sub_u32 v210, v208, v210
v_add_u32 v209, s54, v209
v_cmp_gt_u32 vcc, 224, v209
v_cmp_gt_u32 s[18:19], 24, v210
v_mul_u32_u24 v211, 384, v209
v_lshl_add_u32 v211, v210, 4, v211
v_cndmask_b32 v211, v212, v211, vcc
v_cndmask_b32 v7, v212, v211, s[18:19]
v_add_u32 v208, 128, v1
v_mul_u32_u24 v209, 2622, v208
v_lshrrev_b32 v209, 16, v209
v_mul_u32_u24 v210, 25, v209
v_sub_u32 v210, v208, v210
v_add_u32 v209, s54, v209
v_cmp_gt_u32 vcc, 224, v209
v_cmp_gt_u32 s[18:19], 24, v210
v_mul_u32_u24 v211, 384, v209
v_lshl_add_u32 v211, v210, 4, v211
v_cndmask_b32 v211, v212, v211, vcc
v_cndmask_b32 v8, v212, v211, s[18:19]
v_add_u32 v208, 192, v1
v_mul_u32_u24 v209, 2622, v208
v_lshrrev_b32 v209, 16, v209
v_mul_u32_u24 v210, 25, v209
v_sub_u32 v210, v208, v210
v_add_u32 v209, s54, v209
v_cmp_gt_u32 vcc, 224, v209
v_cmp_gt_u32 s[18:19], 24, v210
v_mul_u32_u24 v211, 384, v209
v_lshl_add_u32 v211, v210, 4, v211
v_cndmask_b32 v211, v212, v211, vcc
v_cndmask_b32 v9, v212, v211, s[18:19]
v_add_u32 v208, 256, v1
v_mul_u32_u24 v209, 2622, v208
v_lshrrev_b32 v209, 16, v209
v_mul_u32_u24 v210, 25, v209
v_sub_u32 v210, v208, v210
v_add_u32 v209, s54, v209
v_cmp_gt_u32 vcc, 224, v209
v_cmp_gt_u32 s[18:19], 24, v210
v_mul_u32_u24 v211, 384, v209
v_lshl_add_u32 v211, v210, 4, v211
v_cndmask_b32 v211, v212, v211, vcc
v_cndmask_b32 v10, v212, v211, s[18:19]
v_add_u32 v208, 320, v1
v_mul_u32_u24 v209, 2622, v208
v_lshrrev_b32 v209, 16, v209
v_mul_u32_u24 v210, 25, v209
v_sub_u32 v210, v208, v210
v_add_u32 v209, s54, v209
v_cmp_gt_u32 vcc, 224, v209
v_cmp_gt_u32 s[18:19], 24, v210
v_mul_u32_u24 v211, 384, v209
v_lshl_add_u32 v211, v210, 4, v211
v_cndmask_b32 v211, v212, v211, vcc
v_cndmask_b32 v11, v212, v211, s[18:19]
v_add_u32 v208, 384, v1
v_mul_u32_u24 v209, 2622, v208
v_lshrrev_b32 v209, 16, v209
v_mul_u32_u24 v210, 25, v209
v_sub_u32 v210, v208, v210
v_add_u32 v209, s54, v209
v_cmp_gt_u32 vcc, 224, v209
v_cmp_gt_u32 s[18:19], 24, v210
v_mul_u32_u24 v211, 384, v209
v_lshl_add_u32 v211, v210, 4, v211
v_cndmask_b32 v211, v212, v211, vcc
v_cndmask_b32 v12, v212, v211, s[18:19]
s_add_u32 s54, s49, s48
s_add_u32 s54, s54, -1
s_mul_i32 s60, s54, 86016
s_cmp_lt_u32 s54, 224
s_cselect_b32 s60, s60, 1073741824
s_add_u32 s54, s49, s48
s_add_u32 s54, s54, 3
s_mul_i32 s61, s54, 86016
s_cmp_lt_u32 s54, 224
s_cselect_b32 s61, s61, 1073741824
s_add_u32 s54, s49, s48
s_add_u32 s54, s54, 7
s_mul_i32 s62, s54, 86016
s_cmp_lt_u32 s54, 224
s_cselect_b32 s62, s62, 1073741824
s_add_u32 s54, s49, s48
s_add_u32 s54, s54, 11
s_mul_i32 s63, s54, 86016
s_cmp_lt_u32 s54, 224
s_cselect_b32 s63, s63, 1073741824
s_add_u32 m0, s55, 0
s_nop 0
buffer_load_dwordx4 v6, s[20:23], s60 offen lds
s_add_u32 m0, s55, 1024
s_nop 0
buffer_load_dwordx4 v7, s[20:23], s60 offen lds
s_add_u32 m0, s55, 2048
s_nop 0
buffer_load_dwordx4 v8, s[20:23], s60 offen lds
s_add_u32 m0, s55, 3072
s_nop 0
buffer_load_dwordx4 v9, s[20:23], s60 offen lds
s_add_u32 m0, s55, 4096
s_nop 0
buffer_load_dwordx4 v10, s[20:23], s60 offen lds
s_add_u32 m0, s55, 5120
s_nop 0
buffer_load_dwordx4 v11, s[20:23], s60 offen lds
s_add_u32 m0, s55, 6144
s_mov_b64 exec, 0xffff
buffer_load_dwordx4 v12, s[20:23], s60 offen lds
s_mov_b64 exec, -1
v_lshlrev_b32 v208, 1, v2
v_subrev_u32 v4, 7, v208
v_subrev_u32 v209, 16, v208
v_cmp_gt_u32 vcc, 4, v2
s_nop 1
v_cndmask_b32 v4, v4, v208, vcc
v_cmp_lt_u32 vcc, 11, v2
s_nop 1
v_cndmask_b32 v4, v4, v209, vcc
s_mov_b32 s24, s6
s_mov_b32 s25, s7
s_mov_b32 s26, 4816896
s_mov_b32 s27, 0x00020000
s_lshr_b32 s73, s49, 1
s_add_u32 s54, s73, -1
s_mul_i32 s64, s54, 43008
s_cmp_lt_u32 s54, 112
s_cselect_b32 s64, s64, 1073741824
s_add_u32 s54, s73, 0
s_mul_i32 s65, s54, 43008
s_cmp_lt_u32 s54, 112
s_cselect_b32 s65, s65, 1073741824
s_add_u32 s54, s73, 1
s_mul_i32 s66, s54, 43008
s_cmp_lt_u32 s54, 112
s_cselect_b32 s66, s66, 1073741824
s_add_u32 s54, s73, 2
s_mul_i32 s67, s54, 43008
s_cmp_lt_u32 s54, 112
s_cselect_b32 s67, s67, 1073741824
s_add_u32 s54, s73, 3
s_mul_i32 s68, s54, 43008
s_cmp_lt_u32 s54, 112
s_cselect_b32 s68, s68, 1073741824
s_add_u32 s54, s73, 4
s_mul_i32 s69, s54, 43008
s_cmp_lt_u32 s54, 112
s_cselect_b32 s69, s69, 1073741824
s_add_u32 s54, s73, 5
s_mul_i32 s70, s54, 43008
s_cmp_lt_u32 s54, 112
s_cselect_b32 s70, s70, 1073741824
s_add_u32 s54, s73, 6
s_mul_i32 s71, s54, 43008
s_cmp_lt_u32 s54, 112
s_cselect_b32 s71, s71, 1073741824
s_add_u32 s54, s73, 7
s_mul_i32 s72, s54, 43008
s_cmp_lt_u32 s54, 112
s_cselect_b32 s72, s72, 1073741824
s_sub_u32 s54, s50, 1
v_add_u32 v208, s54, v4
v_ashrrev_i32 v208, 1, v208
v_mul_u32_u24 v209, 384, v208
v_lshlrev_b32 v210, 4, v3
v_add3_u32 v209, v209, v210, s52
v_cmp_gt_u32 vcc, 112, v208
v_lshlrev_b32 v30, 3, v3
s_sub_u32 s54, s57, s52
v_sub_u32 v30, s54, v30
v_cndmask_b32 v28, v212, v209, vcc
v_add_u32 v207, v28, v30
buffer_load_dwordx4 v[32:35], v28, s[24:27], s64 offen
buffer_load_dwordx2 v[36:37], v207, s[24:27], s64 offen
buffer_load_dwordx4 v[38:41], v28, s[24:27], s65 offen
buffer_load_dwordx2 v[42:43], v207, s[24:27], s65 offen
s_mov_b32 s36, s12
s_mov_b32 s37, s13
s_mov_b32 s38, 19267584
s_mov_b32 s39, 0x00020000
s_mov_b32 s40, s14
s_mov_b32 s41, s15
s_mov_b32 s42, 256
s_mov_b32 s43, 0x00020000
s_mov_b32 s44, s16
s_mov_b32 s45, s17
s_mov_b32 s46, 884736
s_mov_b32 s47, 0x00020000
s_waitcnt vmcnt(11)
s_barrier
ds_read_b64_tr_b16 a[128:129], v243 offset:0
ds_read_b64_tr_b16 a[130:131], v243 offset:1536
ds_read_b64_tr_b16 a[132:133], v244 offset:0
ds_read_b64_tr_b16 a[134:135], v244 offset:1536
ds_read_b64_tr_b16 a[136:137], v245 offset:0
ds_read_b64_tr_b16 a[138:139], v245 offset:1536
ds_read_b64_tr_b16 a[140:141], v243 offset:12288
ds_read_b64_tr_b16 a[142:143], v243 offset:13824
ds_read_b64_tr_b16 a[144:145], v244 offset:12288
ds_read_b64_tr_b16 a[146:147], v244 offset:13824
ds_read_b64_tr_b16 a[148:149], v245 offset:12288
ds_read_b64_tr_b16 a[150:151], v245 offset:13824
ds_read_b64_tr_b16 a[152:153], v243 offset:24576
ds_read_b64_tr_b16 a[154:155], v243 offset:26112
ds_read_b64_tr_b16 a[156:157], v244 offset:24576
ds_read_b64_tr_b16 a[158:159], v244 offset:26112
ds_read_b64_tr_b16 a[160:161], v245 offset:24576
ds_read_b64_tr_b16 a[162:163], v245 offset:26112
ds_read_b64_tr_b16 a[164:165], v243 offset:36864
ds_read_b64_tr_b16 a[166:167], v243 offset:38400
ds_read_b64_tr_b16 a[168:169], v244 offset:36864
ds_read_b64_tr_b16 a[170:171], v244 offset:38400
ds_read_b64_tr_b16 a[172:173], v245 offset:36864
ds_read_b64_tr_b16 a[174:175], v245 offset:38400
ds_read_b64_tr_b16 a[176:177], v243 offset:49152
ds_read_b64_tr_b16 a[178:179], v243 offset:50688
ds_read_b64_tr_b16 a[180:181], v244 offset:49152
ds_read_b64_tr_b16 a[182:183], v244 offset:50688
ds_read_b64_tr_b16 a[184:185], v245 offset:49152
ds_read_b64_tr_b16 a[186:187], v245 offset:50688
ds_read_b64_tr_b16 a[188:189], v243 offset:61440
ds_read_b64_tr_b16 a[190:191], v243 offset:62976
ds_read_b64_tr_b16 a[192:193], v244 offset:61440
ds_read_b64_tr_b16 a[194:195], v244 offset:62976
ds_read_b64_tr_b16 a[196:197], v245 offset:61440
ds_read_b64_tr_b16 a[198:199], v245 offset:62976
s_lshl_b32 s54, s48, 11
s_add_u32 s54, s54, 153216
v_lshl_add_u32 v14, v1, 3, s54
v_lshlrev_b32 v164, 16, v86
v_lshlrev_b32 v165, 16, v90
v_lshlrev_b32 v166, 16, v94
v_and_b32 v167, 0xffff0000, v86
v_and_b32 v168, 0xffff0000, v90
v_and_b32 v169, 0xffff0000, v94
v_lshlrev_b32 v172, 16, v87
v_lshlrev_b32 v173, 16, v91
v_lshlrev_b32 v174, 16, v95
v_and_b32 v175, 0xffff0000, v87
v_and_b32 v176, 0xffff0000, v91
v_and_b32 v177, 0xffff0000, v95
v_lshlrev_b32 v180, 16, v88
v_lshlrev_b32 v181, 16, v92
v_lshlrev_b32 v182, 16, v96
v_and_b32 v183, 0xffff0000, v88
v_and_b32 v184, 0xffff0000, v92
v_and_b32 v185, 0xffff0000, v96
v_lshlrev_b32 v188, 16, v89
v_lshlrev_b32 v189, 16, v93
v_lshlrev_b32 v190, 16, v97
v_and_b32 v191, 0xffff0000, v89
v_and_b32 v192, 0xffff0000, v93
v_and_b32 v193, 0xffff0000, v97
v_add_f32 v164, v164, v166
v_add_f32 v167, v167, v169
v_add_f32 v172, v172, v174
v_add_f32 v175, v175, v177
v_add_f32 v180, v180, v182
v_add_f32 v183, v183, v185
v_add_f32 v188, v188, v190
v_add_f32 v191, v191, v193
v_add_f32 v166, v164, v165
v_add_f32 v169, v167, v168
v_sub_f32 v164, v164, v165
v_sub_f32 v167, v167, v168
v_add_f32 v174, v172, v173
v_add_f32 v177, v175, v176
v_sub_f32 v172, v172, v173
v_sub_f32 v175, v175, v176
v_add_f32 v182, v180, v181
v_add_f32 v185, v183, v184
v_sub_f32 v180, v180, v181
v_sub_f32 v183, v183, v184
v_add_f32 v190, v188, v189
v_add_f32 v193, v191, v192
v_sub_f32 v188, v188, v189
v_sub_f32 v191, v191, v192
v_mul_f32 v166, 0.5, v166
v_mul_f32 v169, 0.5, v169
v_mul_f32 v174, 0.5, v174
v_mul_f32 v177, 0.5, v177
v_mul_f32 v182, 0.5, v182
v_mul_f32 v185, 0.5, v185
v_mul_f32 v190, 0.5, v190
v_mul_f32 v193, 0.5, v193
v_cvt_pk_bf16_f32 v140, v166, v169
v_cvt_pk_bf16_f32 v144, v164, v167
v_cvt_pk_bf16_f32 v141, v174, v177
v_cvt_pk_bf16_f32 v145, v172, v175
v_cvt_pk_bf16_f32 v142, v182, v185
v_cvt_pk_bf16_f32 v146, v180, v183
v_cvt_pk_bf16_f32 v143, v190, v193
v_cvt_pk_bf16_f32 v147, v188, v191
ds_write_b64 v14, v[86:87] offset:0
ds_write_b64 v14, v[88:89] offset:512
ds_write_b64 v14, v[94:95] offset:1024
ds_write_b64 v14, v[96:97] offset:1536
ds_read_b64_tr_b16 v[148:149], v14 offset:0
ds_read_b64_tr_b16 v[150:151], v14 offset:512
ds_read_b64_tr_b16 v[152:153], v14 offset:1024
ds_read_b64_tr_b16 v[154:155], v14 offset:1536
ds_write_b64 v14, v[140:141] offset:0
ds_write_b64 v14, v[142:143] offset:512
ds_write_b64 v14, v[144:145] offset:1024
ds_write_b64 v14, v[146:147] offset:1536
ds_read_b64_tr_b16 v[156:157], v14 offset:0
ds_read_b64_tr_b16 v[158:159], v14 offset:512
ds_read_b64_tr_b16 v[160:161], v14 offset:1024
ds_read_b64_tr_b16 v[162:163], v14 offset:1536
s_mov_b32 s58, 0
s_waitcnt lgkmcnt(10)
buffer_store_dwordx4 v[148:151], v15, s[44:47], s58 offen sc0 sc1
s_mov_b32 s58, 221184
s_waitcnt lgkmcnt(8)
buffer_store_dwordx4 v[152:155], v15, s[44:47], s58 offen sc0 sc1
s_mov_b32 s58, 442368
s_waitcnt lgkmcnt(2)
buffer_store_dwordx4 v[156:159], v15, s[44:47], s58 offen sc0 sc1
s_mov_b32 s58, 663552
s_waitcnt lgkmcnt(0)
buffer_store_dwordx4 v[160:163], v15, s[44:47], s58 offen sc0 sc1
v_cmp_eq_u32 vcc, 0, v0
s_nop 1
v_cndmask_b32 v31, v212, v0, vcc
v_add_u32 v31, s59, v31
s_add_u32 m0, s55, 26496
s_nop 0
buffer_load_dwordx4 v6, s[20:23], s61 offen lds
s_add_u32 m0, s55, 27520
s_nop 0
buffer_load_dwordx4 v7, s[20:23], s61 offen lds
s_add_u32 m0, s55, 28544
s_nop 0
buffer_load_dwordx4 v8, s[20:23], s61 offen lds
s_add_u32 m0, s55, 29568
s_nop 0
buffer_load_dwordx4 v9, s[20:23], s61 offen lds
s_add_u32 m0, s55, 30592
s_nop 0
buffer_load_dwordx4 v10, s[20:23], s61 offen lds
s_add_u32 m0, s55, 31616
s_nop 0
buffer_load_dwordx4 v11, s[20:23], s61 offen lds
s_add_u32 m0, s55, 32640
s_mov_b64 exec, 0xffff
buffer_load_dwordx4 v12, s[20:23], s61 offen lds
s_mov_b64 exec, -1
v_mul_u32_u24 v208, 400, v4
v_add_u32 v17, v208, v5
v_add_u32 v18, 52992, v17
v_add_u32 v1, 126720, v17
v_lshlrev_b32 v210, 4, v3
v_add3_u32 v26, v208, v210, s52
v_add_u32 v27, 46368, v26
v_add_u32 v14, v26, v30
v_add_u32 v15, v27, v30
v_add_u32 v210, s52, v210
v_add_u32 v208, 0, v4
v_mul_u32_u24 v209, 4682, v208
v_lshrrev_b32 v209, 16, v209
v_mul_u32_u24 v211, 14, v209
v_sub_u32 v211, v208, v211
v_mul_u32_u24 v200, 6624, v209
v_mul_u32_u24 v19, 400, v211
v_add3_u32 v19, v19, v200, v5
v_mul_u32_u24 v209, 172032, v209
v_mul_u32_u24 v211, 384, v211
v_add3_u32 v200, v209, v211, v210
v_add_u32 v208, 16, v4
v_mul_u32_u24 v209, 4682, v208
v_lshrrev_b32 v209, 16, v209
v_mul_u32_u24 v211, 14, v209
v_sub_u32 v211, v208, v211
v_mul_u32_u24 v201, 6624, v209
v_mul_u32_u24 v20, 400, v211
v_add3_u32 v20, v20, v201, v5
v_mul_u32_u24 v209, 172032, v209
v_mul_u32_u24 v211, 384, v211
v_add3_u32 v201, v209, v211, v210
v_add_u32 v208, 32, v4
v_mul_u32_u24 v209, 4682, v208
v_lshrrev_b32 v209, 16, v209
v_mul_u32_u24 v211, 14, v209
v_sub_u32 v211, v208, v211
v_mul_u32_u24 v202, 6624, v209
v_mul_u32_u24 v21, 400, v211
v_add3_u32 v21, v21, v202, v5
v_mul_u32_u24 v209, 172032, v209
v_mul_u32_u24 v211, 384, v211
v_add3_u32 v202, v209, v211, v210
v_add_u32 v208, 48, v4
v_mul_u32_u24 v209, 4682, v208
v_lshrrev_b32 v209, 16, v209
v_mul_u32_u24 v211, 14, v209
v_sub_u32 v211, v208, v211
v_mul_u32_u24 v203, 6624, v209
v_mul_u32_u24 v22, 400, v211
v_add3_u32 v22, v22, v203, v5
v_mul_u32_u24 v209, 172032, v209
v_mul_u32_u24 v211, 384, v211
v_add3_u32 v203, v209, v211, v210
v_add_u32 v208, 64, v4
v_mul_u32_u24 v209, 4682, v208
v_lshrrev_b32 v209, 16, v209
v_mul_u32_u24 v211, 14, v209
v_sub_u32 v211, v208, v211
v_mul_u32_u24 v204, 6624, v209
v_mul_u32_u24 v23, 400, v211
v_add3_u32 v23, v23, v204, v5
v_mul_u32_u24 v209, 172032, v209
v_mul_u32_u24 v211, 384, v211
v_add3_u32 v204, v209, v211, v210
v_add_u32 v208, 80, v4
v_mul_u32_u24 v209, 4682, v208
v_lshrrev_b32 v209, 16, v209
v_mul_u32_u24 v211, 14, v209
v_sub_u32 v211, v208, v211
v_mul_u32_u24 v205, 6624, v209
v_mul_u32_u24 v24, 400, v211
v_add3_u32 v24, v24, v205, v5
v_mul_u32_u24 v209, 172032, v209
v_mul_u32_u24 v211, 384, v211
v_add3_u32 v205, v209, v211, v210
v_add_u32 v208, 96, v4
v_mul_u32_u24 v209, 4682, v208
v_lshrrev_b32 v209, 16, v209
v_mul_u32_u24 v211, 14, v209
v_sub_u32 v211, v208, v211
v_mul_u32_u24 v206, 6624, v209
v_mul_u32_u24 v25, 400, v211
v_add3_u32 v25, v25, v206, v5
v_mul_u32_u24 v209, 172032, v209
v_mul_u32_u24 v211, 384, v211
v_add3_u32 v206, v209, v211, v210
v_cmp_gt_u32 vcc, 98, v208
s_nop 1
v_cndmask_b32 v206, v212, v206, vcc
v_add_u32 v209, 106848, v5
v_cndmask_b32 v2, v209, v25, vcc
v_add_u32 v209, 153216, v5
v_cndmask_b32 v25, v209, v25, vcc
s_mul_i32 s56, s49, 224
s_add_u32 s56, s56, s50
s_mul_i32 s56, s56, 384
s_add_u32 s57, s56, 86016
s_waitcnt vmcnt(14)
v_lshlrev_b32 v214, 16, v32
v_and_b32 v215, 0xffff0000, v32
v_lshlrev_b32 v216, 16, v33
v_and_b32 v217, 0xffff0000, v33
v_lshlrev_b32 v218, 16, v34
v_and_b32 v219, 0xffff0000, v34
v_lshlrev_b32 v220, 16, v35
v_and_b32 v221, 0xffff0000, v35
s_waitcnt vmcnt(13)
v_lshlrev_b32 v222, 16, v36
v_and_b32 v223, 0xffff0000, v36
v_lshlrev_b32 v224, 16, v37
v_and_b32 v225, 0xffff0000, v37
s_waitcnt vmcnt(7)
s_barrier
v_mov_b32 v208, 1
buffer_atomic_add v208, v31, s[40:43], 0 offen sc1
ds_read_b128 a[200:203], v17 offset:0
ds_read_b128 a[204:207], v17 offset:64
ds_read_b128 a[208:211], v17 offset:128
ds_read_b128 a[212:215], v17 offset:192
ds_read_b128 a[216:219], v17 offset:256
ds_read_b128 a[220:223], v17 offset:320
v_mov_b32 v148, 0
v_mov_b32 v149, 0
v_mov_b32 v150, 0
v_mov_b32 v151, 0
s_and_b32 s54, s48, 1
s_lshl_b32 s54, s54, 10
s_add_u32 s54, s54, 153216
v_add_u32 v208, s54, v13
ds_write_b128 v208, v[148:151] offset:0
buffer_load_dwordx4 v[44:47], v28, s[24:27], s66 offen
buffer_load_dwordx2 v[48:49], v207, s[24:27], s66 offen
s_add_u32 m0, s55, 126720
s_nop 0
buffer_load_dwordx4 v6, s[20:23], s62 offen lds
s_add_u32 m0, s55, 127744
s_nop 0
buffer_load_dwordx4 v7, s[20:23], s62 offen lds
s_add_u32 m0, s55, 128768
s_nop 0
buffer_load_dwordx4 v8, s[20:23], s62 offen lds
s_add_u32 m0, s55, 129792
s_nop 0
buffer_load_dwordx4 v9, s[20:23], s62 offen lds
s_add_u32 m0, s55, 130816
s_nop 0
buffer_load_dwordx4 v10, s[20:23], s62 offen lds
s_waitcnt lgkmcnt(6)
v_mfma_f32_16x16x32_bf16 v[104:107], a[128:131], a[200:203], v[214:217]
s_add_u32 m0, s55, 131840
s_nop 0
buffer_load_dwordx4 v11, s[20:23], s62 offen lds
v_mfma_f32_16x16x32_bf16 v[108:111], a[132:135], a[200:203], v[218:221]
s_add_u32 m0, s55, 132864
s_mov_b64 exec, 0xffff
buffer_load_dwordx4 v12, s[20:23], s62 offen lds
s_mov_b64 exec, -1
v_mfma_f32_16x16x32_bf16 v[112:115], a[136:139], a[200:203], v[222:225]
ds_read_b128 a[200:203], v17 offset:6624
buffer_load_dwordx4 v[50:53], v28, s[24:27], s67 offen
s_waitcnt lgkmcnt(4)
v_mfma_f32_16x16x32_bf16 v[104:107], a[140:143], a[204:207], v[104:107]
buffer_load_dwordx2 v[54:55], v207, s[24:27], s67 offen
v_mfma_f32_16x16x32_bf16 v[108:111], a[144:147], a[204:207], v[108:111]
buffer_load_dwordx4 v[56:59], v28, s[24:27], s68 offen
v_mfma_f32_16x16x32_bf16 v[112:115], a[148:151], a[204:207], v[112:115]
ds_read_b128 a[204:207], v17 offset:6688
v_lshlrev_b32 v226, 16, v38
v_mfma_f32_16x16x32_bf16 v[104:107], a[152:155], a[208:211], v[104:107]
v_and_b32 v227, 0xffff0000, v38
v_mfma_f32_16x16x32_bf16 v[108:111], a[156:159], a[208:211], v[108:111]
v_lshlrev_b32 v228, 16, v39
v_mfma_f32_16x16x32_bf16 v[112:115], a[160:163], a[208:211], v[112:115]
ds_read_b128 a[208:211], v17 offset:6752
v_and_b32 v229, 0xffff0000, v39
v_mfma_f32_16x16x32_bf16 v[104:107], a[164:167], a[212:215], v[104:107]
v_lshlrev_b32 v230, 16, v40
v_mfma_f32_16x16x32_bf16 v[108:111], a[168:171], a[212:215], v[108:111]
v_and_b32 v231, 0xffff0000, v40
v_mfma_f32_16x16x32_bf16 v[112:115], a[172:175], a[212:215], v[112:115]
ds_read_b128 a[212:215], v17 offset:6816
v_lshlrev_b32 v232, 16, v41
s_waitcnt lgkmcnt(4)
v_mfma_f32_16x16x32_bf16 v[104:107], a[176:179], a[216:219], v[104:107]
v_and_b32 v233, 0xffff0000, v41
v_mfma_f32_16x16x32_bf16 v[108:111], a[180:183], a[216:219], v[108:111]
v_lshlrev_b32 v234, 16, v42
v_mfma_f32_16x16x32_bf16 v[112:115], a[184:187], a[216:219], v[112:115]
ds_read_b128 a[216:219], v17 offset:6880
v_and_b32 v235, 0xffff0000, v42
v_mfma_f32_16x16x32_bf16 v[104:107], a[188:191], a[220:223], v[104:107]
v_lshlrev_b32 v236, 16, v43
v_mfma_f32_16x16x32_bf16 v[108:111], a[192:195], a[220:223], v[108:111]
v_and_b32 v237, 0xffff0000, v43
v_mfma_f32_16x16x32_bf16 v[112:115], a[196:199], a[220:223], v[112:115]
ds_read_b128 a[220:223], v17 offset:6944
s_waitcnt lgkmcnt(4)
v_mfma_f32_16x16x32_bf16 v[116:119], a[128:131], a[200:203], v[226:229]
buffer_load_dwordx2 v[60:61], v207, s[24:27], s68 offen
v_mfma_f32_16x16x32_bf16 v[120:123], a[132:135], a[200:203], v[230:233]
v_mfma_f32_16x16x32_bf16 v[124:127], a[136:139], a[200:203], v[234:237]
ds_read_b128 a[200:203], v17 offset:13248
v_mfma_f32_16x16x32_bf16 v[116:119], a[140:143], a[204:207], v[116:119]
s_add_u32 m0, s55, 79488
s_nop 0
buffer_load_dwordx4 v6, s[20:23], s63 offen lds
v_mfma_f32_16x16x32_bf16 v[120:123], a[144:147], a[204:207], v[120:123]
v_mfma_f32_16x16x32_bf16 v[124:127], a[148:151], a[204:207], v[124:127]
ds_read_b128 a[204:207], v17 offset:13312
s_waitcnt lgkmcnt(4)
v_mfma_f32_16x16x32_bf16 v[116:119], a[152:155], a[208:211], v[116:119]
v_mfma_f32_16x16x32_bf16 v[120:123], a[156:159], a[208:211], v[120:123]
s_add_u32 m0, s55, 80512
s_nop 0
buffer_load_dwordx4 v7, s[20:23], s63 offen lds
v_mfma_f32_16x16x32_bf16 v[124:127], a[160:163], a[208:211], v[124:127]
ds_read_b128 a[208:211], v17 offset:13376
v_mfma_f32_16x16x32_bf16 v[116:119], a[164:167], a[212:215], v[116:119]
v_mfma_f32_16x16x32_bf16 v[120:123], a[168:171], a[212:215], v[120:123]
s_add_u32 m0, s55, 81536
s_nop 0
buffer_load_dwordx4 v8, s[20:23], s63 offen lds
v_mfma_f32_16x16x32_bf16 v[124:127], a[172:175], a[212:215], v[124:127]
ds_read_b128 a[212:215], v17 offset:13440
s_waitcnt lgkmcnt(4)
v_mfma_f32_16x16x32_bf16 v[116:119], a[176:179], a[216:219], v[116:119]
v_mfma_f32_16x16x32_bf16 v[120:123], a[180:183], a[216:219], v[120:123]
v_mfma_f32_16x16x32_bf16 v[124:127], a[184:187], a[216:219], v[124:127]
ds_read_b128 a[216:219], v17 offset:13504
s_add_u32 m0, s55, 82560
s_nop 0
buffer_load_dwordx4 v9, s[20:23], s63 offen lds
v_mfma_f32_16x16x32_bf16 v[116:119], a[188:191], a[220:223], v[116:119]
v_mfma_f32_16x16x32_bf16 v[120:123], a[192:195], a[220:223], v[120:123]
v_mfma_f32_16x16x32_bf16 v[124:127], a[196:199], a[220:223], v[124:127]
ds_read_b128 a[220:223], v17 offset:13568
s_waitcnt lgkmcnt(4)
v_mfma_f32_16x16x32_bf16 v[128:131], a[128:131], a[200:203], v[226:229]
s_add_u32 m0, s55, 83584
s_nop 0
buffer_load_dwordx4 v10, s[20:23], s63 offen lds
v_mfma_f32_16x16x32_bf16 v[132:135], a[132:135], a[200:203], v[230:233]
s_add_u32 m0, s55, 84608
s_nop 0
buffer_load_dwordx4 v11, s[20:23], s63 offen lds
v_mfma_f32_16x16x32_bf16 v[136:139], a[136:139], a[200:203], v[234:237]
ds_read_b128 a[200:203], v17 offset:19872
s_add_u32 m0, s55, 85632
s_mov_b64 exec, 0xffff
buffer_load_dwordx4 v12, s[20:23], s63 offen lds
s_mov_b64 exec, -1
v_mfma_f32_16x16x32_bf16 v[128:131], a[140:143], a[204:207], v[128:131]
buffer_load_dwordx4 v[62:65], v28, s[24:27], s69 offen
v_mfma_f32_16x16x32_bf16 v[132:135], a[144:147], a[204:207], v[132:135]
buffer_load_dwordx2 v[66:67], v207, s[24:27], s69 offen
v_mfma_f32_16x16x32_bf16 v[136:139], a[148:151], a[204:207], v[136:139]
ds_read_b128 a[204:207], v17 offset:19936
s_waitcnt vmcnt(21)
v_lshlrev_b32 v214, 16, v44
s_waitcnt lgkmcnt(3)
v_mfma_f32_16x16x32_bf16 v[128:131], a[152:155], a[208:211], v[128:131]
v_and_b32 v215, 0xffff0000, v44
v_mfma_f32_16x16x32_bf16 v[132:135], a[156:159], a[208:211], v[132:135]
v_lshlrev_b32 v216, 16, v45
v_mfma_f32_16x16x32_bf16 v[136:139], a[160:163], a[208:211], v[136:139]
ds_read_b128 a[208:211], v17 offset:20000
v_and_b32 v217, 0xffff0000, v45
v_mfma_f32_16x16x32_bf16 v[128:131], a[164:167], a[212:215], v[128:131]
v_lshlrev_b32 v218, 16, v46
v_mfma_f32_16x16x32_bf16 v[132:135], a[168:171], a[212:215], v[132:135]
v_and_b32 v219, 0xffff0000, v46
v_mfma_f32_16x16x32_bf16 v[136:139], a[172:175], a[212:215], v[136:139]
ds_read_b128 a[212:215], v17 offset:20064
v_lshlrev_b32 v220, 16, v47
v_mfma_f32_16x16x32_bf16 v[128:131], a[176:179], a[216:219], v[128:131]
v_and_b32 v221, 0xffff0000, v47
v_mfma_f32_16x16x32_bf16 v[132:135], a[180:183], a[216:219], v[132:135]
s_waitcnt vmcnt(20)
v_lshlrev_b32 v222, 16, v48
v_mfma_f32_16x16x32_bf16 v[136:139], a[184:187], a[216:219], v[136:139]
ds_read_b128 a[216:219], v17 offset:20128
v_and_b32 v223, 0xffff0000, v48
s_waitcnt lgkmcnt(4)
v_mfma_f32_16x16x32_bf16 v[128:131], a[188:191], a[220:223], v[128:131]
v_lshlrev_b32 v224, 16, v49
v_mfma_f32_16x16x32_bf16 v[132:135], a[192:195], a[220:223], v[132:135]
v_and_b32 v225, 0xffff0000, v49
v_mfma_f32_16x16x32_bf16 v[136:139], a[196:199], a[220:223], v[136:139]
ds_read_b128 a[220:223], v17 offset:20192
s_waitcnt lgkmcnt(0)
s_barrier
v_mfma_f32_16x16x32_bf16 v[140:143], a[128:131], a[200:203], v[214:217]
buffer_load_dwordx4 v[68:71], v28, s[24:27], s70 offen
v_mfma_f32_16x16x32_bf16 v[144:147], a[132:135], a[200:203], v[218:221]
v_mfma_f32_16x16x32_bf16 v[148:151], a[136:139], a[200:203], v[222:225]
ds_read_b128 a[200:203], v17 offset:26496
v_mfma_f32_16x16x32_bf16 v[140:143], a[140:143], a[204:207], v[140:143]
buffer_load_dwordx2 v[72:73], v207, s[24:27], s70 offen
v_mfma_f32_16x16x32_bf16 v[144:147], a[144:147], a[204:207], v[144:147]
v_mfma_f32_16x16x32_bf16 v[148:151], a[148:151], a[204:207], v[148:151]
ds_read_b128 a[204:207], v17 offset:26560
v_mfma_f32_16x16x32_bf16 v[140:143], a[152:155], a[208:211], v[140:143]
v_mfma_f32_16x16x32_bf16 v[144:147], a[156:159], a[208:211], v[144:147]
buffer_load_dwordx4 v[74:77], v28, s[24:27], s71 offen
v_mfma_f32_16x16x32_bf16 v[148:151], a[160:163], a[208:211], v[148:151]
ds_read_b128 a[208:211], v17 offset:26624
v_mfma_f32_16x16x32_bf16 v[140:143], a[164:167], a[212:215], v[140:143]
v_mfma_f32_16x16x32_bf16 v[144:147], a[168:171], a[212:215], v[144:147]
buffer_load_dwordx2 v[78:79], v207, s[24:27], s71 offen
v_mfma_f32_16x16x32_bf16 v[148:151], a[172:175], a[212:215], v[148:151]
ds_read_b128 a[212:215], v17 offset:26688
v_mfma_f32_16x16x32_bf16 v[140:143], a[176:179], a[216:219], v[140:143]
v_mfma_f32_16x16x32_bf16 v[144:147], a[180:183], a[216:219], v[144:147]
v_mfma_f32_16x16x32_bf16 v[148:151], a[184:187], a[216:219], v[148:151]
ds_read_b128 a[216:219], v17 offset:26752
buffer_load_dwordx4 v[80:83], v28, s[24:27], s72 offen
v_mfma_f32_16x16x32_bf16 v[140:143], a[188:191], a[220:223], v[140:143]
v_mfma_f32_16x16x32_bf16 v[144:147], a[192:195], a[220:223], v[144:147]
v_mfma_f32_16x16x32_bf16 v[148:151], a[196:199], a[220:223], v[148:151]
ds_read_b128 a[220:223], v17 offset:26816
s_waitcnt lgkmcnt(4)
v_mfma_f32_16x16x32_bf16 v[152:155], a[128:131], a[200:203], v[214:217]
buffer_load_dwordx2 v[84:85], v207, s[24:27], s72 offen
s_waitcnt vmcnt(18)
v_lshlrev_b32 v226, 16, v50
v_and_b32 v227, 0xffff0000, v50
v_lshlrev_b32 v228, 16, v51
v_mfma_f32_16x16x32_bf16 v[156:159], a[132:135], a[200:203], v[218:221]
v_and_b32 v229, 0xffff0000, v51
v_lshlrev_b32 v230, 16, v52
v_and_b32 v231, 0xffff0000, v52
v_mfma_f32_16x16x32_bf16 v[160:163], a[136:139], a[200:203], v[222:225]
ds_read_b128 a[200:203], v17 offset:33120
v_lshlrev_b32 v232, 16, v53
v_and_b32 v233, 0xffff0000, v53
s_waitcnt vmcnt(17)
v_lshlrev_b32 v234, 16, v54
v_mfma_f32_16x16x32_bf16 v[152:155], a[140:143], a[204:207], v[152:155]
v_and_b32 v235, 0xffff0000, v54
v_lshlrev_b32 v236, 16, v55
v_and_b32 v237, 0xffff0000, v55
v_mfma_f32_16x16x32_bf16 v[156:159], a[144:147], a[204:207], v[156:159]
v_sub_f32 v244, v104, v128
v_sub_f32 v245, v105, v129
v_sub_f32 v246, v106, v130
v_mfma_f32_16x16x32_bf16 v[160:163], a[148:151], a[204:207], v[160:163]
ds_read_b128 a[204:207], v17 offset:33184
v_sub_f32 v247, v107, v131
v_sub_f32 v248, v108, v132
v_sub_f32 v249, v109, v133
s_waitcnt lgkmcnt(3)
v_mfma_f32_16x16x32_bf16 v[152:155], a[152:155], a[208:211], v[152:155]
v_sub_f32 v250, v110, v134
v_sub_f32 v251, v111, v135
v_sub_f32 v252, v112, v136
v_sub_f32 v253, v113, v137
v_mfma_f32_16x16x32_bf16 v[156:159], a[156:159], a[208:211], v[156:159]
v_sub_f32 v254, v114, v138
v_sub_f32 v255, v115, v139
v_cvt_pk_bf16_f32 v238, v244, v245
v_mfma_f32_16x16x32_bf16 v[160:163], a[160:163], a[208:211], v[160:163]
ds_read_b128 a[208:211], v17 offset:33248
v_cvt_pk_bf16_f32 v239, v246, v247
v_cvt_pk_bf16_f32 v240, v248, v249
v_cvt_pk_bf16_f32 v241, v250, v251
v_mfma_f32_16x16x32_bf16 v[152:155], a[164:167], a[212:215], v[152:155]
v_cvt_pk_bf16_f32 v242, v252, v253
v_cvt_pk_bf16_f32 v243, v254, v255
ds_write_b128 v26, v[238:241] offset:0
v_mfma_f32_16x16x32_bf16 v[156:159], a[168:171], a[212:215], v[156:159]
ds_write_b64 v14, v[242:243] offset:0
v_sub_f32 v92, v116, v140
v_sub_f32 v93, v117, v141
v_mfma_f32_16x16x32_bf16 v[160:163], a[172:175], a[212:215], v[160:163]
ds_read_b128 a[212:215], v17 offset:33312
v_sub_f32 v94, v118, v142
v_sub_f32 v95, v119, v143
v_sub_f32 v96, v120, v144
v_mfma_f32_16x16x32_bf16 v[152:155], a[176:179], a[216:219], v[152:155]
v_sub_f32 v97, v121, v145
v_sub_f32 v98, v122, v146
v_sub_f32 v99, v123, v147
v_sub_f32 v100, v124, v148
v_mfma_f32_16x16x32_bf16 v[156:159], a[180:183], a[216:219], v[156:159]
v_sub_f32 v101, v125, v149
v_sub_f32 v102, v126, v150
v_sub_f32 v103, v127, v151
v_mfma_f32_16x16x32_bf16 v[160:163], a[184:187], a[216:219], v[160:163]
ds_read_b128 a[216:219], v17 offset:33376
v_cvt_pk_bf16_f32 v86, v92, v93
v_cvt_pk_bf16_f32 v87, v94, v95
v_cvt_pk_bf16_f32 v88, v96, v97
s_waitcnt lgkmcnt(5)
v_mfma_f32_16x16x32_bf16 v[152:155], a[188:191], a[220:223], v[152:155]
v_cvt_pk_bf16_f32 v89, v98, v99
v_cvt_pk_bf16_f32 v90, v100, v101
v_cvt_pk_bf16_f32 v91, v102, v103
v_mfma_f32_16x16x32_bf16 v[156:159], a[192:195], a[220:223], v[156:159]
v_accvgpr_write_b32 a0, v86
v_accvgpr_write_b32 a1, v87
v_accvgpr_write_b32 a2, v88
v_mfma_f32_16x16x32_bf16 v[160:163], a[196:199], a[220:223], v[160:163]
ds_read_b128 a[220:223], v17 offset:33440
v_accvgpr_write_b32 a3, v89
v_accvgpr_write_b32 a4, v90
v_accvgpr_write_b32 a5, v91
v_mfma_f32_16x16x32_bf16 v[164:167], a[128:131], a[200:203], v[226:229]
v_add_f32 v244, v116, v128
v_add_f32 v245, v117, v129
v_add_f32 v246, v118, v130
v_mfma_f32_16x16x32_bf16 v[168:171], a[132:135], a[200:203], v[230:233]
v_add_f32 v247, v119, v131
v_add_f32 v248, v120, v132
v_add_f32 v249, v121, v133
v_mfma_f32_16x16x32_bf16 v[172:175], a[136:139], a[200:203], v[234:237]
ds_read_b128 a[200:203], v17 offset:39744
v_add_f32 v250, v122, v134
v_add_f32 v251, v123, v135
v_mfma_f32_16x16x32_bf16 v[164:167], a[140:143], a[204:207], v[164:167]
v_add_f32 v252, v124, v136
v_add_f32 v253, v125, v137
v_add_f32 v254, v126, v138
v_mfma_f32_16x16x32_bf16 v[168:171], a[144:147], a[204:207], v[168:171]
v_add_f32 v255, v127, v139
v_cvt_pk_bf16_f32 v238, v244, v245
v_cvt_pk_bf16_f32 v239, v246, v247
v_mfma_f32_16x16x32_bf16 v[172:175], a[148:151], a[204:207], v[172:175]
ds_read_b128 a[204:207], v17 offset:39808
v_cvt_pk_bf16_f32 v240, v248, v249
v_cvt_pk_bf16_f32 v241, v250, v251
s_waitcnt lgkmcnt(3)
v_mfma_f32_16x16x32_bf16 v[164:167], a[152:155], a[208:211], v[164:167]
v_cvt_pk_bf16_f32 v242, v252, v253
v_cvt_pk_bf16_f32 v243, v254, v255
v_accvgpr_write_b32 a42, v238
v_mfma_f32_16x16x32_bf16 v[168:171], a[156:159], a[208:211], v[168:171]
v_accvgpr_write_b32 a43, v239
v_accvgpr_write_b32 a44, v240
v_accvgpr_write_b32 a45, v241
v_mfma_f32_16x16x32_bf16 v[172:175], a[160:163], a[208:211], v[172:175]
ds_read_b128 a[208:211], v17 offset:39872
v_accvgpr_write_b32 a46, v242
v_accvgpr_write_b32 a47, v243
v_mfma_f32_16x16x32_bf16 v[164:167], a[164:167], a[212:215], v[164:167]
v_sub_f32 v92, v128, v116
v_sub_f32 v93, v129, v117
v_sub_f32 v94, v130, v118
v_mfma_f32_16x16x32_bf16 v[168:171], a[168:171], a[212:215], v[168:171]
v_sub_f32 v95, v131, v119
v_sub_f32 v96, v132, v120
v_sub_f32 v97, v133, v121
v_mfma_f32_16x16x32_bf16 v[172:175], a[172:175], a[212:215], v[172:175]
ds_read_b128 a[212:215], v17 offset:39936
v_sub_f32 v98, v134, v122
v_sub_f32 v99, v135, v123
v_mfma_f32_16x16x32_bf16 v[164:167], a[176:179], a[216:219], v[164:167]
v_sub_f32 v100, v136, v124
v_sub_f32 v101, v137, v125
v_sub_f32 v102, v138, v126
v_mfma_f32_16x16x32_bf16 v[168:171], a[180:183], a[216:219], v[168:171]
v_sub_f32 v103, v139, v127
v_cvt_pk_bf16_f32 v86, v92, v93
v_cvt_pk_bf16_f32 v87, v94, v95
v_mfma_f32_16x16x32_bf16 v[172:175], a[184:187], a[216:219], v[172:175]
ds_read_b128 a[216:219], v17 offset:40000
v_cvt_pk_bf16_f32 v88, v96, v97
v_cvt_pk_bf16_f32 v89, v98, v99
s_waitcnt lgkmcnt(3)
v_mfma_f32_16x16x32_bf16 v[164:167], a[188:191], a[220:223], v[164:167]
v_cvt_pk_bf16_f32 v90, v100, v101
v_cvt_pk_bf16_f32 v91, v102, v103
v_accvgpr_write_b32 a84, v86
v_mfma_f32_16x16x32_bf16 v[168:171], a[192:195], a[220:223], v[168:171]
v_accvgpr_write_b32 a85, v87
v_accvgpr_write_b32 a86, v88
v_accvgpr_write_b32 a87, v89
v_mfma_f32_16x16x32_bf16 v[172:175], a[196:199], a[220:223], v[172:175]
ds_read_b128 a[220:223], v17 offset:40064
v_accvgpr_write_b32 a88, v90
v_accvgpr_write_b32 a89, v91
v_mfma_f32_16x16x32_bf16 v[176:179], a[128:131], a[200:203], v[226:229]
s_waitcnt vmcnt(16)
v_lshlrev_b32 v214, 16, v56
v_and_b32 v215, 0xffff0000, v56
v_lshlrev_b32 v216, 16, v57
v_and_b32 v217, 0xffff0000, v57
v_mfma_f32_16x16x32_bf16 v[180:183], a[132:135], a[200:203], v[230:233]
v_lshlrev_b32 v218, 16, v58
v_and_b32 v219, 0xffff0000, v58
v_lshlrev_b32 v220, 16, v59
v_mfma_f32_16x16x32_bf16 v[184:187], a[136:139], a[200:203], v[234:237]
ds_read_b128 a[200:203], v17 offset:46368
v_and_b32 v221, 0xffff0000, v59
s_waitcnt vmcnt(15)
v_lshlrev_b32 v222, 16, v60
v_and_b32 v223, 0xffff0000, v60
v_mfma_f32_16x16x32_bf16 v[176:179], a[140:143], a[204:207], v[176:179]
v_lshlrev_b32 v224, 16, v61
v_and_b32 v225, 0xffff0000, v61
v_sub_f32 v244, v128, v152
v_mfma_f32_16x16x32_bf16 v[180:183], a[144:147], a[204:207], v[180:183]
v_sub_f32 v245, v129, v153
v_sub_f32 v246, v130, v154
v_sub_f32 v247, v131, v155
v_mfma_f32_16x16x32_bf16 v[184:187], a[148:151], a[204:207], v[184:187]
ds_read_b128 a[204:207], v17 offset:46432
v_sub_f32 v248, v132, v156
v_sub_f32 v249, v133, v157
v_sub_f32 v250, v134, v158
s_waitcnt lgkmcnt(3)
v_mfma_f32_16x16x32_bf16 v[176:179], a[152:155], a[208:211], v[176:179]
v_sub_f32 v251, v135, v159
v_sub_f32 v252, v136, v160
v_sub_f32 v253, v137, v161
v_mfma_f32_16x16x32_bf16 v[180:183], a[156:159], a[208:211], v[180:183]
v_sub_f32 v254, v138, v162
v_sub_f32 v255, v139, v163
v_cvt_pk_bf16_f32 v238, v244, v245
v_mfma_f32_16x16x32_bf16 v[184:187], a[160:163], a[208:211], v[184:187]
ds_read_b128 a[208:211], v17 offset:46496
v_cvt_pk_bf16_f32 v239, v246, v247
v_cvt_pk_bf16_f32 v240, v248, v249
v_cvt_pk_bf16_f32 v241, v250, v251
v_mfma_f32_16x16x32_bf16 v[176:179], a[164:167], a[212:215], v[176:179]
v_cvt_pk_bf16_f32 v242, v252, v253
v_cvt_pk_bf16_f32 v243, v254, v255
ds_write_b128 v26, v[238:241] offset:6624
ds_write_b64 v14, v[242:243] offset:6624
v_mfma_f32_16x16x32_bf16 v[180:183], a[168:171], a[212:215], v[180:183]
v_sub_f32 v92, v140, v164
v_sub_f32 v93, v141, v165
v_sub_f32 v94, v142, v166
v_mfma_f32_16x16x32_bf16 v[184:187], a[172:175], a[212:215], v[184:187]
ds_read_b128 a[212:215], v17 offset:46560
v_sub_f32 v95, v143, v167
v_sub_f32 v96, v144, v168
v_sub_f32 v97, v145, v169
v_mfma_f32_16x16x32_bf16 v[176:179], a[176:179], a[216:219], v[176:179]
v_sub_f32 v98, v146, v170
v_sub_f32 v99, v147, v171
v_sub_f32 v100, v148, v172
v_mfma_f32_16x16x32_bf16 v[180:183], a[180:183], a[216:219], v[180:183]
v_sub_f32 v101, v149, v173
v_sub_f32 v102, v150, v174
v_sub_f32 v103, v151, v175
v_mfma_f32_16x16x32_bf16 v[184:187], a[184:187], a[216:219], v[184:187]
ds_read_b128 a[216:219], v17 offset:46624
v_cvt_pk_bf16_f32 v86, v92, v93
v_cvt_pk_bf16_f32 v87, v94, v95
v_cvt_pk_bf16_f32 v88, v96, v97
s_waitcnt lgkmcnt(5)
v_mfma_f32_16x16x32_bf16 v[176:179], a[188:191], a[220:223], v[176:179]
v_cvt_pk_bf16_f32 v89, v98, v99
v_cvt_pk_bf16_f32 v90, v100, v101
v_cvt_pk_bf16_f32 v91, v102, v103
v_mfma_f32_16x16x32_bf16 v[180:183], a[192:195], a[220:223], v[180:183]
v_accvgpr_write_b32 a6, v86
v_accvgpr_write_b32 a7, v87
v_accvgpr_write_b32 a8, v88
v_mfma_f32_16x16x32_bf16 v[184:187], a[196:199], a[220:223], v[184:187]
ds_read_b128 a[220:223], v17 offset:46688
v_accvgpr_write_b32 a9, v89
v_accvgpr_write_b32 a10, v90
v_accvgpr_write_b32 a11, v91
s_waitcnt lgkmcnt(0)
s_barrier
v_mfma_f32_16x16x32_bf16 v[188:191], a[128:131], a[200:203], v[214:217]
v_add_f32 v244, v140, v152
v_add_f32 v245, v141, v153
v_add_f32 v246, v142, v154
v_mfma_f32_16x16x32_bf16 v[192:195], a[132:135], a[200:203], v[218:221]
v_add_f32 v247, v143, v155
v_add_f32 v248, v144, v156
v_add_f32 v249, v145, v157
v_mfma_f32_16x16x32_bf16 v[196:199], a[136:139], a[200:203], v[222:225]
ds_read_b128 a[200:203], v1 offset:0
v_add_f32 v250, v146, v158
v_add_f32 v251, v147, v159
v_mfma_f32_16x16x32_bf16 v[188:191], a[140:143], a[204:207], v[188:191]
v_add_f32 v252, v148, v160
v_add_f32 v253, v149, v161
v_add_f32 v254, v150, v162
v_mfma_f32_16x16x32_bf16 v[192:195], a[144:147], a[204:207], v[192:195]
v_add_f32 v255, v151, v163
v_cvt_pk_bf16_f32 v238, v244, v245
v_cvt_pk_bf16_f32 v239, v246, v247
v_mfma_f32_16x16x32_bf16 v[196:199], a[148:151], a[204:207], v[196:199]
ds_read_b128 a[204:207], v1 offset:64
v_cvt_pk_bf16_f32 v240, v248, v249
v_cvt_pk_bf16_f32 v241, v250, v251
v_mfma_f32_16x16x32_bf16 v[188:191], a[152:155], a[208:211], v[188:191]
v_cvt_pk_bf16_f32 v242, v252, v253
v_cvt_pk_bf16_f32 v243, v254, v255
v_accvgpr_write_b32 a48, v238
v_mfma_f32_16x16x32_bf16 v[192:195], a[156:159], a[208:211], v[192:195]
v_accvgpr_write_b32 a49, v239
v_accvgpr_write_b32 a50, v240
v_accvgpr_write_b32 a51, v241
v_mfma_f32_16x16x32_bf16 v[196:199], a[160:163], a[208:211], v[196:199]
ds_read_b128 a[208:211], v1 offset:128
v_accvgpr_write_b32 a52, v242
v_accvgpr_write_b32 a53, v243
v_mfma_f32_16x16x32_bf16 v[188:191], a[164:167], a[212:215], v[188:191]
v_sub_f32 v92, v152, v140
v_sub_f32 v93, v153, v141
v_sub_f32 v94, v154, v142
v_mfma_f32_16x16x32_bf16 v[192:195], a[168:171], a[212:215], v[192:195]
v_sub_f32 v95, v155, v143
v_sub_f32 v96, v156, v144
v_sub_f32 v97, v157, v145
v_mfma_f32_16x16x32_bf16 v[196:199], a[172:175], a[212:215], v[196:199]
ds_read_b128 a[212:215], v1 offset:192
v_sub_f32 v98, v158, v146
v_sub_f32 v99, v159, v147
v_mfma_f32_16x16x32_bf16 v[188:191], a[176:179], a[216:219], v[188:191]
v_sub_f32 v100, v160, v148
v_sub_f32 v101, v161, v149
v_sub_f32 v102, v162, v150
v_mfma_f32_16x16x32_bf16 v[192:195], a[180:183], a[216:219], v[192:195]
v_sub_f32 v103, v163, v151
v_cvt_pk_bf16_f32 v86, v92, v93
v_cvt_pk_bf16_f32 v87, v94, v95
v_mfma_f32_16x16x32_bf16 v[196:199], a[184:187], a[216:219], v[196:199]
ds_read_b128 a[216:219], v1 offset:256
v_cvt_pk_bf16_f32 v88, v96, v97
v_cvt_pk_bf16_f32 v89, v98, v99
v_mfma_f32_16x16x32_bf16 v[188:191], a[188:191], a[220:223], v[188:191]
v_cvt_pk_bf16_f32 v90, v100, v101
v_cvt_pk_bf16_f32 v91, v102, v103
v_accvgpr_write_b32 a90, v86
v_mfma_f32_16x16x32_bf16 v[192:195], a[192:195], a[220:223], v[192:195]
v_accvgpr_write_b32 a91, v87
v_accvgpr_write_b32 a92, v88
v_accvgpr_write_b32 a93, v89
v_mfma_f32_16x16x32_bf16 v[196:199], a[196:199], a[220:223], v[196:199]
ds_read_b128 a[220:223], v1 offset:320
v_accvgpr_write_b32 a94, v90
v_accvgpr_write_b32 a95, v91
s_waitcnt lgkmcnt(3)
v_mfma_f32_16x16x32_bf16 v[104:107], a[128:131], a[200:203], v[214:217]
s_waitcnt vmcnt(7)
v_lshlrev_b32 v226, 16, v62
v_and_b32 v227, 0xffff0000, v62
v_lshlrev_b32 v228, 16, v63
v_and_b32 v229, 0xffff0000, v63
v_mfma_f32_16x16x32_bf16 v[108:111], a[132:135], a[200:203], v[218:221]
v_lshlrev_b32 v230, 16, v64
v_and_b32 v231, 0xffff0000, v64
v_lshlrev_b32 v232, 16, v65
v_mfma_f32_16x16x32_bf16 v[112:115], a[136:139], a[200:203], v[222:225]
ds_read_b128 a[200:203], v1 offset:6624
v_and_b32 v233, 0xffff0000, v65
s_waitcnt vmcnt(6)
v_lshlrev_b32 v234, 16, v66
v_and_b32 v235, 0xffff0000, v66
v_mfma_f32_16x16x32_bf16 v[104:107], a[140:143], a[204:207], v[104:107]
v_lshlrev_b32 v236, 16, v67
v_and_b32 v237, 0xffff0000, v67
v_sub_f32 v244, v152, v176
v_mfma_f32_16x16x32_bf16 v[108:111], a[144:147], a[204:207], v[108:111]
v_sub_f32 v245, v153, v177
v_sub_f32 v246, v154, v178
v_sub_f32 v247, v155, v179
v_mfma_f32_16x16x32_bf16 v[112:115], a[148:151], a[204:207], v[112:115]
ds_read_b128 a[204:207], v1 offset:6688
v_sub_f32 v248, v156, v180
v_sub_f32 v249, v157, v181
v_sub_f32 v250, v158, v182
v_mfma_f32_16x16x32_bf16 v[104:107], a[152:155], a[208:211], v[104:107]
v_sub_f32 v251, v159, v183
v_sub_f32 v252, v160, v184
v_sub_f32 v253, v161, v185
v_mfma_f32_16x16x32_bf16 v[108:111], a[156:159], a[208:211], v[108:111]
v_sub_f32 v254, v162, v186
v_sub_f32 v255, v163, v187
v_cvt_pk_bf16_f32 v238, v244, v245
v_mfma_f32_16x16x32_bf16 v[112:115], a[160:163], a[208:211], v[112:115]
ds_read_b128 a[208:211], v1 offset:6752
v_cvt_pk_bf16_f32 v239, v246, v247
v_cvt_pk_bf16_f32 v240, v248, v249
v_cvt_pk_bf16_f32 v241, v250, v251
s_waitcnt lgkmcnt(3)
v_mfma_f32_16x16x32_bf16 v[104:107], a[164:167], a[212:215], v[104:107]
v_cvt_pk_bf16_f32 v242, v252, v253
v_cvt_pk_bf16_f32 v243, v254, v255
ds_write_b128 v26, v[238:241] offset:13248
ds_write_b64 v14, v[242:243] offset:13248
v_mfma_f32_16x16x32_bf16 v[108:111], a[168:171], a[212:215], v[108:111]
v_sub_f32 v92, v164, v188
v_sub_f32 v93, v165, v189
v_sub_f32 v94, v166, v190
v_mfma_f32_16x16x32_bf16 v[112:115], a[172:175], a[212:215], v[112:115]
ds_read_b128 a[212:215], v1 offset:6816
v_sub_f32 v95, v167, v191
v_sub_f32 v96, v168, v192
v_sub_f32 v97, v169, v193
v_mfma_f32_16x16x32_bf16 v[104:107], a[176:179], a[216:219], v[104:107]
v_sub_f32 v98, v170, v194
v_sub_f32 v99, v171, v195
v_sub_f32 v100, v172, v196
v_mfma_f32_16x16x32_bf16 v[108:111], a[180:183], a[216:219], v[108:111]
v_sub_f32 v101, v173, v197
v_sub_f32 v102, v174, v198
v_sub_f32 v103, v175, v199
v_mfma_f32_16x16x32_bf16 v[112:115], a[184:187], a[216:219], v[112:115]
ds_read_b128 a[216:219], v1 offset:6880
v_cvt_pk_bf16_f32 v86, v92, v93
v_cvt_pk_bf16_f32 v87, v94, v95
v_cvt_pk_bf16_f32 v88, v96, v97
v_mfma_f32_16x16x32_bf16 v[104:107], a[188:191], a[220:223], v[104:107]
v_cvt_pk_bf16_f32 v89, v98, v99
v_cvt_pk_bf16_f32 v90, v100, v101
v_cvt_pk_bf16_f32 v91, v102, v103
v_mfma_f32_16x16x32_bf16 v[108:111], a[192:195], a[220:223], v[108:111]
v_accvgpr_write_b32 a12, v86
v_accvgpr_write_b32 a13, v87
v_accvgpr_write_b32 a14, v88
v_mfma_f32_16x16x32_bf16 v[112:115], a[196:199], a[220:223], v[112:115]
ds_read_b128 a[220:223], v1 offset:6944
v_accvgpr_write_b32 a15, v89
v_accvgpr_write_b32 a16, v90
v_accvgpr_write_b32 a17, v91
s_waitcnt lgkmcnt(4)
v_mfma_f32_16x16x32_bf16 v[116:119], a[128:131], a[200:203], v[226:229]
v_mov_b32 v29, 0
buffer_load_dword v16, v29, s[40:43], 0 offen sc1
v_add_f32 v244, v164, v176
v_add_f32 v245, v165, v177
v_mfma_f32_16x16x32_bf16 v[120:123], a[132:135], a[200:203], v[230:233]
v_add_f32 v246, v166, v178
v_add_f32 v247, v167, v179
v_add_f32 v248, v168, v180
v_mfma_f32_16x16x32_bf16 v[124:127], a[136:139], a[200:203], v[234:237]
ds_read_b128 a[200:203], v1 offset:13248
v_add_f32 v249, v169, v181
v_add_f32 v250, v170, v182
v_add_f32 v251, v171, v183
v_mfma_f32_16x16x32_bf16 v[116:119], a[140:143], a[204:207], v[116:119]
v_add_f32 v252, v172, v184
v_add_f32 v253, v173, v185
v_mfma_f32_16x16x32_bf16 v[120:123], a[144:147], a[204:207], v[120:123]
v_add_f32 v254, v174, v186
v_add_f32 v255, v175, v187
v_cvt_pk_bf16_f32 v238, v244, v245
v_mfma_f32_16x16x32_bf16 v[124:127], a[148:151], a[204:207], v[124:127]
ds_read_b128 a[204:207], v1 offset:13312
v_cvt_pk_bf16_f32 v239, v246, v247
v_cvt_pk_bf16_f32 v240, v248, v249
v_cvt_pk_bf16_f32 v241, v250, v251
v_mfma_f32_16x16x32_bf16 v[116:119], a[152:155], a[208:211], v[116:119]
v_cvt_pk_bf16_f32 v242, v252, v253
v_cvt_pk_bf16_f32 v243, v254, v255
v_accvgpr_write_b32 a54, v238
v_mfma_f32_16x16x32_bf16 v[120:123], a[156:159], a[208:211], v[120:123]
v_accvgpr_write_b32 a55, v239
v_accvgpr_write_b32 a56, v240
v_mfma_f32_16x16x32_bf16 v[124:127], a[160:163], a[208:211], v[124:127]
ds_read_b128 a[208:211], v1 offset:13376
v_accvgpr_write_b32 a57, v241
v_accvgpr_write_b32 a58, v242
v_accvgpr_write_b32 a59, v243
s_waitcnt lgkmcnt(3)
v_mfma_f32_16x16x32_bf16 v[116:119], a[164:167], a[212:215], v[116:119]
v_sub_f32 v92, v176, v164
v_sub_f32 v93, v177, v165
v_sub_f32 v94, v178, v166
v_mfma_f32_16x16x32_bf16 v[120:123], a[168:171], a[212:215], v[120:123]
v_sub_f32 v95, v179, v167
v_sub_f32 v96, v180, v168
v_mfma_f32_16x16x32_bf16 v[124:127], a[172:175], a[212:215], v[124:127]
ds_read_b128 a[212:215], v1 offset:13440
v_sub_f32 v97, v181, v169
v_sub_f32 v98, v182, v170
v_sub_f32 v99, v183, v171
v_mfma_f32_16x16x32_bf16 v[116:119], a[176:179], a[216:219], v[116:119]
v_sub_f32 v100, v184, v172
v_sub_f32 v101, v185, v173
v_sub_f32 v102, v186, v174
v_mfma_f32_16x16x32_bf16 v[120:123], a[180:183], a[216:219], v[120:123]
v_sub_f32 v103, v187, v175
v_cvt_pk_bf16_f32 v86, v92, v93
v_cvt_pk_bf16_f32 v87, v94, v95
v_mfma_f32_16x16x32_bf16 v[124:127], a[184:187], a[216:219], v[124:127]
ds_read_b128 a[216:219], v1 offset:13504
v_cvt_pk_bf16_f32 v88, v96, v97
v_cvt_pk_bf16_f32 v89, v98, v99
v_mfma_f32_16x16x32_bf16 v[116:119], a[188:191], a[220:223], v[116:119]
v_cvt_pk_bf16_f32 v90, v100, v101
v_cvt_pk_bf16_f32 v91, v102, v103
v_accvgpr_write_b32 a96, v86
v_mfma_f32_16x16x32_bf16 v[120:123], a[192:195], a[220:223], v[120:123]
v_accvgpr_write_b32 a97, v87
v_accvgpr_write_b32 a98, v88
v_accvgpr_write_b32 a99, v89
v_mfma_f32_16x16x32_bf16 v[124:127], a[196:199], a[220:223], v[124:127]
ds_read_b128 a[220:223], v1 offset:13568
v_accvgpr_write_b32 a100, v90
v_accvgpr_write_b32 a101, v91
s_waitcnt lgkmcnt(3)
v_mfma_f32_16x16x32_bf16 v[128:131], a[128:131], a[200:203], v[226:229]
s_waitcnt vmcnt(6)
v_lshlrev_b32 v214, 16, v68
v_and_b32 v215, 0xffff0000, v68
v_lshlrev_b32 v216, 16, v69
v_and_b32 v217, 0xffff0000, v69
v_mfma_f32_16x16x32_bf16 v[132:135], a[132:135], a[200:203], v[230:233]
v_lshlrev_b32 v218, 16, v70
v_and_b32 v219, 0xffff0000, v70
v_lshlrev_b32 v220, 16, v71
v_mfma_f32_16x16x32_bf16 v[136:139], a[136:139], a[200:203], v[234:237]
ds_read_b128 a[200:203], v1 offset:19872
v_and_b32 v221, 0xffff0000, v71
s_waitcnt vmcnt(5)
v_lshlrev_b32 v222, 16, v72
v_and_b32 v223, 0xffff0000, v72
v_mfma_f32_16x16x32_bf16 v[128:131], a[140:143], a[204:207], v[128:131]
v_lshlrev_b32 v224, 16, v73
v_and_b32 v225, 0xffff0000, v73
v_sub_f32 v244, v176, v104
v_mfma_f32_16x16x32_bf16 v[132:135], a[144:147], a[204:207], v[132:135]
v_sub_f32 v245, v177, v105
v_sub_f32 v246, v178, v106
v_sub_f32 v247, v179, v107
v_mfma_f32_16x16x32_bf16 v[136:139], a[148:151], a[204:207], v[136:139]
ds_read_b128 a[204:207], v1 offset:19936
v_sub_f32 v248, v180, v108
v_sub_f32 v249, v181, v109
v_sub_f32 v250, v182, v110
v_mfma_f32_16x16x32_bf16 v[128:131], a[152:155], a[208:211], v[128:131]
v_sub_f32 v251, v183, v111
v_sub_f32 v252, v184, v112
v_sub_f32 v253, v185, v113
v_mfma_f32_16x16x32_bf16 v[132:135], a[156:159], a[208:211], v[132:135]
v_sub_f32 v254, v186, v114
v_sub_f32 v255, v187, v115
v_cvt_pk_bf16_f32 v238, v244, v245
v_mfma_f32_16x16x32_bf16 v[136:139], a[160:163], a[208:211], v[136:139]
ds_read_b128 a[208:211], v1 offset:20000
v_cvt_pk_bf16_f32 v239, v246, v247
v_cvt_pk_bf16_f32 v240, v248, v249
v_cvt_pk_bf16_f32 v241, v250, v251
s_waitcnt lgkmcnt(3)
v_mfma_f32_16x16x32_bf16 v[128:131], a[164:167], a[212:215], v[128:131]
v_cvt_pk_bf16_f32 v242, v252, v253
v_cvt_pk_bf16_f32 v243, v254, v255
ds_write_b128 v26, v[238:241] offset:19872
ds_write_b64 v14, v[242:243] offset:19872
v_mfma_f32_16x16x32_bf16 v[132:135], a[168:171], a[212:215], v[132:135]
v_sub_f32 v92, v188, v116
v_sub_f32 v93, v189, v117
v_sub_f32 v94, v190, v118
v_mfma_f32_16x16x32_bf16 v[136:139], a[172:175], a[212:215], v[136:139]
ds_read_b128 a[212:215], v1 offset:20064
v_sub_f32 v95, v191, v119
v_sub_f32 v96, v192, v120
v_sub_f32 v97, v193, v121
v_mfma_f32_16x16x32_bf16 v[128:131], a[176:179], a[216:219], v[128:131]
v_sub_f32 v98, v194, v122
v_sub_f32 v99, v195, v123
v_sub_f32 v100, v196, v124
v_mfma_f32_16x16x32_bf16 v[132:135], a[180:183], a[216:219], v[132:135]
v_sub_f32 v101, v197, v125
v_sub_f32 v102, v198, v126
v_sub_f32 v103, v199, v127
v_mfma_f32_16x16x32_bf16 v[136:139], a[184:187], a[216:219], v[136:139]
ds_read_b128 a[216:219], v1 offset:20128
v_cvt_pk_bf16_f32 v86, v92, v93
v_cvt_pk_bf16_f32 v87, v94, v95
v_cvt_pk_bf16_f32 v88, v96, v97
v_mfma_f32_16x16x32_bf16 v[128:131], a[188:191], a[220:223], v[128:131]
v_cvt_pk_bf16_f32 v89, v98, v99
v_cvt_pk_bf16_f32 v90, v100, v101
v_cvt_pk_bf16_f32 v91, v102, v103
v_mfma_f32_16x16x32_bf16 v[132:135], a[192:195], a[220:223], v[132:135]
v_accvgpr_write_b32 a18, v86
v_accvgpr_write_b32 a19, v87
v_accvgpr_write_b32 a20, v88
v_mfma_f32_16x16x32_bf16 v[136:139], a[196:199], a[220:223], v[136:139]
ds_read_b128 a[220:223], v1 offset:20192
v_accvgpr_write_b32 a21, v89
v_accvgpr_write_b32 a22, v90
v_accvgpr_write_b32 a23, v91
s_waitcnt lgkmcnt(0)
s_barrier
v_mfma_f32_16x16x32_bf16 v[140:143], a[128:131], a[200:203], v[214:217]
v_add_f32 v244, v188, v104
v_add_f32 v245, v189, v105
v_add_f32 v246, v190, v106
v_mfma_f32_16x16x32_bf16 v[144:147], a[132:135], a[200:203], v[218:221]
v_add_f32 v247, v191, v107
v_add_f32 v248, v192, v108
v_add_f32 v249, v193, v109
v_mfma_f32_16x16x32_bf16 v[148:151], a[136:139], a[200:203], v[222:225]
ds_read_b128 a[200:203], v18 offset:26496
v_add_f32 v250, v194, v110
v_add_f32 v251, v195, v111
v_mfma_f32_16x16x32_bf16 v[140:143], a[140:143], a[204:207], v[140:143]
v_add_f32 v252, v196, v112
v_add_f32 v253, v197, v113
v_add_f32 v254, v198, v114
v_mfma_f32_16x16x32_bf16 v[144:147], a[144:147], a[204:207], v[144:147]
v_add_f32 v255, v199, v115
v_cvt_pk_bf16_f32 v238, v244, v245
v_cvt_pk_bf16_f32 v239, v246, v247
v_mfma_f32_16x16x32_bf16 v[148:151], a[148:151], a[204:207], v[148:151]
ds_read_b128 a[204:207], v18 offset:26560
v_cvt_pk_bf16_f32 v240, v248, v249
v_cvt_pk_bf16_f32 v241, v250, v251
v_mfma_f32_16x16x32_bf16 v[140:143], a[152:155], a[208:211], v[140:143]
v_cvt_pk_bf16_f32 v242, v252, v253
v_cvt_pk_bf16_f32 v243, v254, v255
v_accvgpr_write_b32 a60, v238
v_mfma_f32_16x16x32_bf16 v[144:147], a[156:159], a[208:211], v[144:147]
v_accvgpr_write_b32 a61, v239
v_accvgpr_write_b32 a62, v240
v_accvgpr_write_b32 a63, v241
v_mfma_f32_16x16x32_bf16 v[148:151], a[160:163], a[208:211], v[148:151]
ds_read_b128 a[208:211], v18 offset:26624
v_accvgpr_write_b32 a64, v242
v_accvgpr_write_b32 a65, v243
v_mfma_f32_16x16x32_bf16 v[140:143], a[164:167], a[212:215], v[140:143]
v_sub_f32 v92, v104, v188
v_sub_f32 v93, v105, v189
v_sub_f32 v94, v106, v190
v_mfma_f32_16x16x32_bf16 v[144:147], a[168:171], a[212:215], v[144:147]
v_sub_f32 v95, v107, v191
v_sub_f32 v96, v108, v192
v_sub_f32 v97, v109, v193
v_mfma_f32_16x16x32_bf16 v[148:151], a[172:175], a[212:215], v[148:151]
ds_read_b128 a[212:215], v18 offset:26688
v_sub_f32 v98, v110, v194
v_sub_f32 v99, v111, v195
v_mfma_f32_16x16x32_bf16 v[140:143], a[176:179], a[216:219], v[140:143]
v_sub_f32 v100, v112, v196
v_sub_f32 v101, v113, v197
v_sub_f32 v102, v114, v198
v_mfma_f32_16x16x32_bf16 v[144:147], a[180:183], a[216:219], v[144:147]
v_sub_f32 v103, v115, v199
v_cvt_pk_bf16_f32 v86, v92, v93
v_cvt_pk_bf16_f32 v87, v94, v95
v_mfma_f32_16x16x32_bf16 v[148:151], a[184:187], a[216:219], v[148:151]
ds_read_b128 a[216:219], v18 offset:26752
v_cvt_pk_bf16_f32 v88, v96, v97
v_cvt_pk_bf16_f32 v89, v98, v99
v_mfma_f32_16x16x32_bf16 v[140:143], a[188:191], a[220:223], v[140:143]
v_cvt_pk_bf16_f32 v90, v100, v101
v_cvt_pk_bf16_f32 v91, v102, v103
v_accvgpr_write_b32 a102, v86
v_mfma_f32_16x16x32_bf16 v[144:147], a[192:195], a[220:223], v[144:147]
v_accvgpr_write_b32 a103, v87
v_accvgpr_write_b32 a104, v88
v_accvgpr_write_b32 a105, v89
v_mfma_f32_16x16x32_bf16 v[148:151], a[196:199], a[220:223], v[148:151]
ds_read_b128 a[220:223], v18 offset:26816
v_accvgpr_write_b32 a106, v90
v_accvgpr_write_b32 a107, v91
s_waitcnt lgkmcnt(3)
v_mfma_f32_16x16x32_bf16 v[152:155], a[128:131], a[200:203], v[214:217]
s_waitcnt vmcnt(0)
v_readfirstlane_b32 s54, v16
s_nop 0
s_cmp_ge_u32 s54, 54
s_cbranch_scc1 Lpoll_ok
s_mov_b32 s73, 0
Lpoll:
s_sleep 4
buffer_load_dword v16, v29, s[40:43], 0 offen sc1
s_waitcnt vmcnt(0)
v_readfirstlane_b32 s54, v16
s_add_u32 s73, s73, 1
s_cmp_ge_u32 s73, 0x40000
s_cbranch_scc1 Lpoll_ok
s_cmp_lt_u32 s54, 54
s_cbranch_scc1 Lpoll
Lpoll_ok:
s_add_u32 s58, s3, 0
buffer_load_dwordx4 a[224:227], v13, s[44:47], s58 offen sc1
v_mfma_f32_16x16x32_bf16 v[156:159], a[132:135], a[200:203], v[218:221]
buffer_load_dwordx4 a[228:231], v13, s[44:47], s58 offen offset:1024 sc1
buffer_load_dwordx4 a[232:235], v13, s[44:47], s58 offen offset:2048 sc1
v_mfma_f32_16x16x32_bf16 v[160:163], a[136:139], a[200:203], v[222:225]
ds_read_b128 a[200:203], v18 offset:33120
s_add_u32 s58, s3, 12288
buffer_load_dwordx4 a[236:239], v13, s[44:47], s58 offen sc1
v_mfma_f32_16x16x32_bf16 v[152:155], a[140:143], a[204:207], v[152:155]
buffer_load_dwordx4 a[240:243], v13, s[44:47], s58 offen offset:1024 sc1
buffer_load_dwordx4 a[244:247], v13, s[44:47], s58 offen offset:2048 sc1
s_lshr_b32 s54, s2, 3
s_lshl_b32 s54, s54, 2
s_add_u32 s54, s54, s48
s_mul_i32 s54, s54, 6912
v_lshlrev_b32 v208, 3, v13
v_cmp_gt_u32 vcc, 6912, v208
s_nop 1
v_cndmask_b32 v208, v212, v208, vcc
buffer_load_dword v16, v208, s[44:47], s54 offen sc1
v_mfma_f32_16x16x32_bf16 v[156:159], a[144:147], a[204:207], v[156:159]
v_lshlrev_b32 v226, 16, v74
v_and_b32 v227, 0xffff0000, v74
v_mfma_f32_16x16x32_bf16 v[160:163], a[148:151], a[204:207], v[160:163]
ds_read_b128 a[204:207], v18 offset:33184
v_lshlrev_b32 v228, 16, v75
v_and_b32 v229, 0xffff0000, v75
v_mfma_f32_16x16x32_bf16 v[152:155], a[152:155], a[208:211], v[152:155]
v_lshlrev_b32 v230, 16, v76
v_and_b32 v231, 0xffff0000, v76
v_lshlrev_b32 v232, 16, v77
v_mfma_f32_16x16x32_bf16 v[156:159], a[156:159], a[208:211], v[156:159]
v_and_b32 v233, 0xffff0000, v77
v_lshlrev_b32 v234, 16, v78
v_mfma_f32_16x16x32_bf16 v[160:163], a[160:163], a[208:211], v[160:163]
ds_read_b128 a[208:211], v18 offset:33248
v_and_b32 v235, 0xffff0000, v78
v_lshlrev_b32 v236, 16, v79
s_waitcnt lgkmcnt(3)
v_mfma_f32_16x16x32_bf16 v[152:155], a[164:167], a[212:215], v[152:155]
v_and_b32 v237, 0xffff0000, v79
v_sub_f32 v244, v104, v128
v_sub_f32 v245, v105, v129
v_mfma_f32_16x16x32_bf16 v[156:159], a[168:171], a[212:215], v[156:159]
v_sub_f32 v246, v106, v130
v_sub_f32 v247, v107, v131
v_mfma_f32_16x16x32_bf16 v[160:163], a[172:175], a[212:215], v[160:163]
ds_read_b128 a[212:215], v18 offset:33312
v_sub_f32 v248, v108, v132
v_sub_f32 v249, v109, v133
v_mfma_f32_16x16x32_bf16 v[152:155], a[176:179], a[216:219], v[152:155]
v_sub_f32 v250, v110, v134
v_sub_f32 v251, v111, v135
v_sub_f32 v252, v112, v136
v_mfma_f32_16x16x32_bf16 v[156:159], a[180:183], a[216:219], v[156:159]
v_sub_f32 v253, v113, v137
v_sub_f32 v254, v114, v138
v_mfma_f32_16x16x32_bf16 v[160:163], a[184:187], a[216:219], v[160:163]
ds_read_b128 a[216:219], v18 offset:33376
v_sub_f32 v255, v115, v139
v_cvt_pk_bf16_f32 v238, v244, v245
v_mfma_f32_16x16x32_bf16 v[152:155], a[188:191], a[220:223], v[152:155]
v_cvt_pk_bf16_f32 v239, v246, v247
v_cvt_pk_bf16_f32 v240, v248, v249
v_cvt_pk_bf16_f32 v241, v250, v251
v_mfma_f32_16x16x32_bf16 v[156:159], a[192:195], a[220:223], v[156:159]
v_cvt_pk_bf16_f32 v242, v252, v253
v_cvt_pk_bf16_f32 v243, v254, v255
v_mfma_f32_16x16x32_bf16 v[160:163], a[196:199], a[220:223], v[160:163]
ds_read_b128 a[220:223], v18 offset:33440
ds_write_b128 v26, v[238:241] offset:26496
ds_write_b64 v14, v[242:243] offset:26496
s_waitcnt lgkmcnt(5)
v_mfma_f32_16x16x32_bf16 v[164:167], a[128:131], a[200:203], v[226:229]
v_mfma_f32_16x16x32_bf16 v[168:171], a[132:135], a[200:203], v[230:233]
v_mfma_f32_16x16x32_bf16 v[172:175], a[136:139], a[200:203], v[234:237]
ds_read_b128 a[200:203], v18 offset:39744
v_mfma_f32_16x16x32_bf16 v[164:167], a[140:143], a[204:207], v[164:167]
v_mfma_f32_16x16x32_bf16 v[168:171], a[144:147], a[204:207], v[168:171]
v_mfma_f32_16x16x32_bf16 v[172:175], a[148:151], a[204:207], v[172:175]
ds_read_b128 a[204:207], v18 offset:39808
v_mfma_f32_16x16x32_bf16 v[164:167], a[152:155], a[208:211], v[164:167]
v_mfma_f32_16x16x32_bf16 v[168:171], a[156:159], a[208:211], v[168:171]
v_mfma_f32_16x16x32_bf16 v[172:175], a[160:163], a[208:211], v[172:175]
ds_read_b128 a[208:211], v18 offset:39872
s_waitcnt lgkmcnt(6)
v_mfma_f32_16x16x32_bf16 v[164:167], a[164:167], a[212:215], v[164:167]
v_mfma_f32_16x16x32_bf16 v[168:171], a[168:171], a[212:215], v[168:171]
v_mfma_f32_16x16x32_bf16 v[172:175], a[172:175], a[212:215], v[172:175]
ds_read_b128 a[212:215], v18 offset:39936
v_mfma_f32_16x16x32_bf16 v[164:167], a[176:179], a[216:219], v[164:167]
v_mfma_f32_16x16x32_bf16 v[168:171], a[180:183], a[216:219], v[168:171]
v_mfma_f32_16x16x32_bf16 v[172:175], a[184:187], a[216:219], v[172:175]
ds_read_b128 a[216:219], v18 offset:40000
s_waitcnt lgkmcnt(4)
v_mfma_f32_16x16x32_bf16 v[164:167], a[188:191], a[220:223], v[164:167]
v_mfma_f32_16x16x32_bf16 v[168:171], a[192:195], a[220:223], v[168:171]
v_mfma_f32_16x16x32_bf16 v[172:175], a[196:199], a[220:223], v[172:175]
ds_read_b128 a[220:223], v18 offset:40064
v_mfma_f32_16x16x32_bf16 v[176:179], a[128:131], a[200:203], v[226:229]
v_lshlrev_b32 v214, 16, v80
v_and_b32 v215, 0xffff0000, v80
v_mfma_f32_16x16x32_bf16 v[180:183], a[132:135], a[200:203], v[230:233]
v_lshlrev_b32 v216, 16, v81
v_and_b32 v217, 0xffff0000, v81
v_mfma_f32_16x16x32_bf16 v[184:187], a[136:139], a[200:203], v[234:237]
ds_read_b128 a[200:203], v18 offset:46368
v_lshlrev_b32 v218, 16, v82
v_and_b32 v219, 0xffff0000, v82
s_waitcnt lgkmcnt(4)
v_mfma_f32_16x16x32_bf16 v[176:179], a[140:143], a[204:207], v[176:179]
v_lshlrev_b32 v220, 16, v83
v_and_b32 v221, 0xffff0000, v83
v_mfma_f32_16x16x32_bf16 v[180:183], a[144:147], a[204:207], v[180:183]
v_lshlrev_b32 v222, 16, v84
v_mfma_f32_16x16x32_bf16 v[184:187], a[148:151], a[204:207], v[184:187]
ds_read_b128 a[204:207], v18 offset:46432
v_and_b32 v223, 0xffff0000, v84
v_lshlrev_b32 v224, 16, v85
v_mfma_f32_16x16x32_bf16 v[176:179], a[152:155], a[208:211], v[176:179]
v_and_b32 v225, 0xffff0000, v85
v_sub_f32 v92, v128, v152
v_mfma_f32_16x16x32_bf16 v[180:183], a[156:159], a[208:211], v[180:183]
v_sub_f32 v93, v129, v153
v_sub_f32 v94, v130, v154
v_mfma_f32_16x16x32_bf16 v[184:187], a[160:163], a[208:211], v[184:187]
ds_read_b128 a[208:211], v18 offset:46496
v_sub_f32 v95, v131, v155
s_waitcnt lgkmcnt(4)
v_mfma_f32_16x16x32_bf16 v[176:179], a[164:167], a[212:215], v[176:179]
v_sub_f32 v96, v132, v156
v_sub_f32 v97, v133, v157
v_mfma_f32_16x16x32_bf16 v[180:183], a[168:171], a[212:215], v[180:183]
v_sub_f32 v98, v134, v158
v_sub_f32 v99, v135, v159
v_mfma_f32_16x16x32_bf16 v[184:187], a[172:175], a[212:215], v[184:187]
ds_read_b128 a[212:215], v18 offset:46560
v_sub_f32 v100, v136, v160
v_sub_f32 v101, v137, v161
v_mfma_f32_16x16x32_bf16 v[176:179], a[176:179], a[216:219], v[176:179]
v_sub_f32 v102, v138, v162
v_sub_f32 v103, v139, v163
v_mfma_f32_16x16x32_bf16 v[180:183], a[180:183], a[216:219], v[180:183]
v_cvt_pk_bf16_f32 v86, v92, v93
v_mfma_f32_16x16x32_bf16 v[184:187], a[184:187], a[216:219], v[184:187]
ds_read_b128 a[216:219], v18 offset:46624
v_cvt_pk_bf16_f32 v87, v94, v95
v_cvt_pk_bf16_f32 v88, v96, v97
s_waitcnt lgkmcnt(4)
v_mfma_f32_16x16x32_bf16 v[176:179], a[188:191], a[220:223], v[176:179]
v_cvt_pk_bf16_f32 v89, v98, v99
v_cvt_pk_bf16_f32 v90, v100, v101
v_mfma_f32_16x16x32_bf16 v[180:183], a[192:195], a[220:223], v[180:183]
v_cvt_pk_bf16_f32 v91, v102, v103
ds_write_b128 v26, v[86:89] offset:33120
v_mfma_f32_16x16x32_bf16 v[184:187], a[196:199], a[220:223], v[184:187]
ds_read_b128 a[220:223], v18 offset:46688
ds_write_b64 v14, v[90:91] offset:33120
v_mfma_f32_16x16x32_bf16 v[188:191], a[128:131], a[200:203], v[214:217]
v_sub_f32 v244, v152, v176
v_sub_f32 v245, v153, v177
v_mfma_f32_16x16x32_bf16 v[192:195], a[132:135], a[200:203], v[218:221]
v_sub_f32 v246, v154, v178
v_mfma_f32_16x16x32_bf16 v[196:199], a[136:139], a[200:203], v[222:225]
v_sub_f32 v247, v155, v179
s_waitcnt lgkmcnt(5)
v_mfma_f32_16x16x32_bf16 v[188:191], a[140:143], a[204:207], v[188:191]
v_sub_f32 v248, v156, v180
v_mfma_f32_16x16x32_bf16 v[192:195], a[144:147], a[204:207], v[192:195]
v_sub_f32 v249, v157, v181
v_mfma_f32_16x16x32_bf16 v[196:199], a[148:151], a[204:207], v[196:199]
v_sub_f32 v250, v158, v182
v_mfma_f32_16x16x32_bf16 v[188:191], a[152:155], a[208:211], v[188:191]
v_sub_f32 v251, v159, v183
v_mfma_f32_16x16x32_bf16 v[192:195], a[156:159], a[208:211], v[192:195]
v_sub_f32 v252, v160, v184
v_mfma_f32_16x16x32_bf16 v[196:199], a[160:163], a[208:211], v[196:199]
v_sub_f32 v253, v161, v185
s_waitcnt lgkmcnt(3)
v_mfma_f32_16x16x32_bf16 v[188:191], a[164:167], a[212:215], v[188:191]
v_sub_f32 v254, v162, v186
v_sub_f32 v255, v163, v187
v_mfma_f32_16x16x32_bf16 v[192:195], a[168:171], a[212:215], v[192:195]
v_cvt_pk_bf16_f32 v238, v244, v245
v_mfma_f32_16x16x32_bf16 v[196:199], a[172:175], a[212:215], v[196:199]
v_cvt_pk_bf16_f32 v239, v246, v247
v_mfma_f32_16x16x32_bf16 v[188:191], a[176:179], a[216:219], v[188:191]
v_cvt_pk_bf16_f32 v240, v248, v249
v_mfma_f32_16x16x32_bf16 v[192:195], a[180:183], a[216:219], v[192:195]
v_cvt_pk_bf16_f32 v241, v250, v251
v_mfma_f32_16x16x32_bf16 v[196:199], a[184:187], a[216:219], v[196:199]
v_cvt_pk_bf16_f32 v242, v252, v253
s_waitcnt lgkmcnt(0)
v_mfma_f32_16x16x32_bf16 v[188:191], a[188:191], a[220:223], v[188:191]
v_cvt_pk_bf16_f32 v243, v254, v255
v_mfma_f32_16x16x32_bf16 v[192:195], a[192:195], a[220:223], v[192:195]
ds_write_b128 v26, v[238:241] offset:39744
v_mfma_f32_16x16x32_bf16 v[196:199], a[196:199], a[220:223], v[196:199]
ds_write_b64 v14, v[242:243] offset:39744
s_add_u32 s58, s3, 24576
buffer_load_dwordx4 a[200:203], v13, s[44:47], s58 offen sc1
buffer_load_dwordx4 a[204:207], v13, s[44:47], s58 offen offset:1024 sc1
buffer_load_dwordx4 a[208:211], v13, s[44:47], s58 offen offset:2048 sc1
s_waitcnt lgkmcnt(0)
s_barrier
ds_read_b128 a[128:131], v19 offset:0
ds_read_b128 a[132:135], v20 offset:0
ds_read_b128 a[136:139], v21 offset:0
ds_read_b128 a[140:143], v22 offset:0
ds_read_b128 a[144:147], v23 offset:0
ds_read_b128 a[148:151], v24 offset:0
ds_read_b128 a[152:155], v25 offset:0
s_waitcnt vmcnt(9) lgkmcnt(6)
v_mfma_f32_16x16x32_bf16 v[32:35], a[224:227], a[128:131], 0
s_add_u32 s58, s3, 36864
v_sub_f32 v244, v116, v140
s_waitcnt vmcnt(8)
v_mfma_f32_16x16x32_bf16 v[36:39], a[228:231], a[128:131], 0
buffer_load_dwordx4 a[212:215], v13, s[44:47], s58 offen sc1
s_waitcnt vmcnt(8)
v_mfma_f32_16x16x32_bf16 v[40:43], a[232:235], a[128:131], 0
ds_read_b128 a[128:131], v19 offset:64
s_waitcnt lgkmcnt(6)
v_mfma_f32_16x16x32_bf16 v[52:55], a[232:235], a[132:135], 0
v_sub_f32 v245, v117, v141
v_sub_f32 v246, v118, v142
v_mfma_f32_16x16x32_bf16 v[48:51], a[228:231], a[132:135], 0
buffer_load_dwordx4 a[216:219], v13, s[44:47], s58 offen offset:1024 sc1
v_mfma_f32_16x16x32_bf16 v[44:47], a[224:227], a[132:135], 0
ds_read_b128 a[132:135], v20 offset:64
s_waitcnt lgkmcnt(6)
v_mfma_f32_16x16x32_bf16 v[56:59], a[224:227], a[136:139], 0
v_sub_f32 v247, v119, v143
v_sub_f32 v248, v120, v144
v_mfma_f32_16x16x32_bf16 v[60:63], a[228:231], a[136:139], 0
buffer_load_dwordx4 a[220:223], v13, s[44:47], s58 offen offset:2048 sc1
v_mfma_f32_16x16x32_bf16 v[64:67], a[232:235], a[136:139], 0
ds_read_b128 a[136:139], v21 offset:64
s_waitcnt lgkmcnt(6)
v_mfma_f32_16x16x32_bf16 v[76:79], a[232:235], a[140:143], 0
v_sub_f32 v249, v121, v145
v_sub_f32 v250, v122, v146
v_mfma_f32_16x16x32_bf16 v[72:75], a[228:231], a[140:143], 0
v_sub_f32 v251, v123, v147
v_sub_f32 v252, v124, v148
v_mfma_f32_16x16x32_bf16 v[68:71], a[224:227], a[140:143], 0
ds_read_b128 a[140:143], v22 offset:64
s_waitcnt lgkmcnt(4)
v_mfma_f32_16x16x32_bf16 v[80:83], a[224:227], a[144:147], 0
v_sub_f32 v253, v125, v149
v_sub_f32 v254, v126, v150
v_mfma_f32_16x16x32_bf16 v[84:87], a[228:231], a[144:147], 0
v_sub_f32 v255, v127, v151
v_cvt_pk_bf16_f32 v238, v244, v245
v_mfma_f32_16x16x32_bf16 v[88:91], a[232:235], a[144:147], 0
ds_read_b128 a[144:147], v23 offset:64
v_mfma_f32_16x16x32_bf16 v[100:103], a[232:235], a[148:151], 0
v_cvt_pk_bf16_f32 v239, v246, v247
v_cvt_pk_bf16_f32 v240, v248, v249
v_mfma_f32_16x16x32_bf16 v[96:99], a[228:231], a[148:151], 0
v_cvt_pk_bf16_f32 v241, v250, v251
v_cvt_pk_bf16_f32 v242, v252, v253
v_mfma_f32_16x16x32_bf16 v[92:95], a[224:227], a[148:151], 0
ds_read_b128 a[148:151], v24 offset:64
v_cvt_pk_bf16_f32 v243, v254, v255
v_accvgpr_write_b32 a24, v238
v_mfma_f32_16x16x32_bf16 v[104:107], a[224:227], a[152:155], 0
v_accvgpr_write_b32 a25, v239
v_accvgpr_write_b32 a26, v240
v_mfma_f32_16x16x32_bf16 v[108:111], a[228:231], a[152:155], 0
s_waitcnt vmcnt(7)
v_accvgpr_write_b32 a27, v241
v_accvgpr_write_b32 a28, v242
v_mfma_f32_16x16x32_bf16 v[112:115], a[232:235], a[152:155], 0
ds_read_b128 a[152:155], v25 offset:64
v_accvgpr_write_b32 a29, v243
s_waitcnt lgkmcnt(4)
v_mfma_f32_16x16x32_bf16 v[32:35], a[236:239], a[128:131], v[32:35]
s_add_u32 s58, s3, 49152
v_sub_f32 v244, v140, v164
v_mfma_f32_16x16x32_bf16 v[36:39], a[240:243], a[128:131], v[36:39]
buffer_load_dwordx4 a[224:227], v13, s[44:47], s58 offen sc1
v_mfma_f32_16x16x32_bf16 v[40:43], a[244:247], a[128:131], v[40:43]
ds_read_b128 a[128:131], v19 offset:128
v_mfma_f32_16x16x32_bf16 v[52:55], a[244:247], a[132:135], v[52:55]
v_sub_f32 v245, v141, v165
v_sub_f32 v246, v142, v166
v_mfma_f32_16x16x32_bf16 v[48:51], a[240:243], a[132:135], v[48:51]
buffer_load_dwordx4 a[228:231], v13, s[44:47], s58 offen offset:1024 sc1
v_mfma_f32_16x16x32_bf16 v[44:47], a[236:239], a[132:135], v[44:47]
ds_read_b128 a[132:135], v20 offset:128
v_mfma_f32_16x16x32_bf16 v[56:59], a[236:239], a[136:139], v[56:59]
v_sub_f32 v247, v143, v167
v_sub_f32 v248, v144, v168
v_mfma_f32_16x16x32_bf16 v[60:63], a[240:243], a[136:139], v[60:63]
buffer_load_dwordx4 a[232:235], v13, s[44:47], s58 offen offset:2048 sc1
v_mfma_f32_16x16x32_bf16 v[64:67], a[244:247], a[136:139], v[64:67]
ds_read_b128 a[136:139], v21 offset:128
s_waitcnt lgkmcnt(4)
v_mfma_f32_16x16x32_bf16 v[76:79], a[244:247], a[140:143], v[76:79]
v_sub_f32 v249, v145, v169
v_sub_f32 v250, v146, v170
v_mfma_f32_16x16x32_bf16 v[72:75], a[240:243], a[140:143], v[72:75]
v_sub_f32 v251, v147, v171
v_sub_f32 v252, v148, v172
v_mfma_f32_16x16x32_bf16 v[68:71], a[236:239], a[140:143], v[68:71]
ds_read_b128 a[140:143], v22 offset:128
v_mfma_f32_16x16x32_bf16 v[80:83], a[236:239], a[144:147], v[80:83]
v_sub_f32 v253, v149, v173
v_sub_f32 v254, v150, v174
v_mfma_f32_16x16x32_bf16 v[84:87], a[240:243], a[144:147], v[84:87]
v_sub_f32 v255, v151, v175
v_cvt_pk_bf16_f32 v238, v244, v245
v_mfma_f32_16x16x32_bf16 v[88:91], a[244:247], a[144:147], v[88:91]
ds_read_b128 a[144:147], v23 offset:128
v_mfma_f32_16x16x32_bf16 v[100:103], a[244:247], a[148:151], v[100:103]
v_cvt_pk_bf16_f32 v239, v246, v247
v_cvt_pk_bf16_f32 v240, v248, v249
v_mfma_f32_16x16x32_bf16 v[96:99], a[240:243], a[148:151], v[96:99]
v_cvt_pk_bf16_f32 v241, v250, v251
v_cvt_pk_bf16_f32 v242, v252, v253
v_mfma_f32_16x16x32_bf16 v[92:95], a[236:239], a[148:151], v[92:95]
ds_read_b128 a[148:151], v24 offset:128
v_cvt_pk_bf16_f32 v243, v254, v255
v_accvgpr_write_b32 a30, v238
s_waitcnt lgkmcnt(4)
v_mfma_f32_16x16x32_bf16 v[104:107], a[236:239], a[152:155], v[104:107]
v_accvgpr_write_b32 a31, v239
v_accvgpr_write_b32 a32, v240
v_mfma_f32_16x16x32_bf16 v[108:111], a[240:243], a[152:155], v[108:111]
s_waitcnt vmcnt(6)
v_accvgpr_write_b32 a33, v241
v_accvgpr_write_b32 a34, v242
v_mfma_f32_16x16x32_bf16 v[112:115], a[244:247], a[152:155], v[112:115]
ds_read_b128 a[152:155], v25 offset:128
v_accvgpr_write_b32 a35, v243
v_mfma_f32_16x16x32_bf16 v[32:35], a[200:203], a[128:131], v[32:35]
s_add_u32 s58, s3, 61440
v_sub_f32 v244, v164, v188
v_mfma_f32_16x16x32_bf16 v[36:39], a[204:207], a[128:131], v[36:39]
buffer_load_dwordx4 a[236:239], v13, s[44:47], s58 offen sc1
v_mfma_f32_16x16x32_bf16 v[40:43], a[208:211], a[128:131], v[40:43]
ds_read_b128 a[128:131], v19 offset:192
v_mfma_f32_16x16x32_bf16 v[52:55], a[208:211], a[132:135], v[52:55]
v_sub_f32 v245, v165, v189
v_sub_f32 v246, v166, v190
v_mfma_f32_16x16x32_bf16 v[48:51], a[204:207], a[132:135], v[48:51]
buffer_load_dwordx4 a[240:243], v13, s[44:47], s58 offen offset:1024 sc1
v_mfma_f32_16x16x32_bf16 v[44:47], a[200:203], a[132:135], v[44:47]
ds_read_b128 a[132:135], v20 offset:192
s_waitcnt lgkmcnt(4)
v_mfma_f32_16x16x32_bf16 v[56:59], a[200:203], a[136:139], v[56:59]
v_sub_f32 v247, v167, v191
v_sub_f32 v248, v168, v192
v_mfma_f32_16x16x32_bf16 v[60:63], a[204:207], a[136:139], v[60:63]
buffer_load_dwordx4 a[244:247], v13, s[44:47], s58 offen offset:2048 sc1
v_mfma_f32_16x16x32_bf16 v[64:67], a[208:211], a[136:139], v[64:67]
ds_read_b128 a[136:139], v21 offset:192
v_mfma_f32_16x16x32_bf16 v[76:79], a[208:211], a[140:143], v[76:79]
v_sub_f32 v249, v169, v193
v_sub_f32 v250, v170, v194
v_mfma_f32_16x16x32_bf16 v[72:75], a[204:207], a[140:143], v[72:75]
v_sub_f32 v251, v171, v195
v_sub_f32 v252, v172, v196
v_mfma_f32_16x16x32_bf16 v[68:71], a[200:203], a[140:143], v[68:71]
ds_read_b128 a[140:143], v22 offset:192
v_mfma_f32_16x16x32_bf16 v[80:83], a[200:203], a[144:147], v[80:83]
v_sub_f32 v253, v173, v197
v_sub_f32 v254, v174, v198
v_mfma_f32_16x16x32_bf16 v[84:87], a[204:207], a[144:147], v[84:87]
v_sub_f32 v255, v175, v199
v_cvt_pk_bf16_f32 v238, v244, v245
v_mfma_f32_16x16x32_bf16 v[88:91], a[208:211], a[144:147], v[88:91]
ds_read_b128 a[144:147], v23 offset:192
s_waitcnt lgkmcnt(4)
v_mfma_f32_16x16x32_bf16 v[100:103], a[208:211], a[148:151], v[100:103]
v_cvt_pk_bf16_f32 v239, v246, v247
v_cvt_pk_bf16_f32 v240, v248, v249
v_mfma_f32_16x16x32_bf16 v[96:99], a[204:207], a[148:151], v[96:99]
v_cvt_pk_bf16_f32 v241, v250, v251
v_cvt_pk_bf16_f32 v242, v252, v253
v_mfma_f32_16x16x32_bf16 v[92:95], a[200:203], a[148:151], v[92:95]
ds_read_b128 a[148:151], v24 offset:192
v_cvt_pk_bf16_f32 v243, v254, v255
v_accvgpr_write_b32 a36, v238
v_mfma_f32_16x16x32_bf16 v[104:107], a[200:203], a[152:155], v[104:107]
v_accvgpr_write_b32 a37, v239
v_accvgpr_write_b32 a38, v240
v_mfma_f32_16x16x32_bf16 v[108:111], a[204:207], a[152:155], v[108:111]
s_waitcnt vmcnt(6)
v_accvgpr_write_b32 a39, v241
v_accvgpr_write_b32 a40, v242
v_mfma_f32_16x16x32_bf16 v[112:115], a[208:211], a[152:155], v[112:115]
ds_read_b128 a[152:155], v25 offset:192
v_accvgpr_write_b32 a41, v243
v_mfma_f32_16x16x32_bf16 v[32:35], a[212:215], a[128:131], v[32:35]
s_add_u32 s58, s3, 73728
v_add_f32 v244, v116, v128
v_mfma_f32_16x16x32_bf16 v[36:39], a[216:219], a[128:131], v[36:39]
buffer_load_dwordx4 a[200:203], v13, s[44:47], s58 offen sc1
v_mfma_f32_16x16x32_bf16 v[40:43], a[220:223], a[128:131], v[40:43]
ds_read_b128 a[128:131], v19 offset:256
s_waitcnt lgkmcnt(4)
v_mfma_f32_16x16x32_bf16 v[52:55], a[220:223], a[132:135], v[52:55]
v_add_f32 v245, v117, v129
v_add_f32 v246, v118, v130
v_mfma_f32_16x16x32_bf16 v[48:51], a[216:219], a[132:135], v[48:51]
buffer_load_dwordx4 a[204:207], v13, s[44:47], s58 offen offset:1024 sc1
v_mfma_f32_16x16x32_bf16 v[44:47], a[212:215], a[132:135], v[44:47]
ds_read_b128 a[132:135], v20 offset:256
v_mfma_f32_16x16x32_bf16 v[56:59], a[212:215], a[136:139], v[56:59]
v_add_f32 v247, v119, v131
v_add_f32 v248, v120, v132
v_mfma_f32_16x16x32_bf16 v[60:63], a[216:219], a[136:139], v[60:63]
buffer_load_dwordx4 a[208:211], v13, s[44:47], s58 offen offset:2048 sc1
v_mfma_f32_16x16x32_bf16 v[64:67], a[220:223], a[136:139], v[64:67]
ds_read_b128 a[136:139], v21 offset:256
v_mfma_f32_16x16x32_bf16 v[76:79], a[220:223], a[140:143], v[76:79]
v_add_f32 v249, v121, v133
v_add_f32 v250, v122, v134
v_mfma_f32_16x16x32_bf16 v[72:75], a[216:219], a[140:143], v[72:75]
v_add_f32 v251, v123, v135
v_add_f32 v252, v124, v136
v_mfma_f32_16x16x32_bf16 v[68:71], a[212:215], a[140:143], v[68:71]
ds_read_b128 a[140:143], v22 offset:256
s_waitcnt lgkmcnt(4)
v_mfma_f32_16x16x32_bf16 v[80:83], a[212:215], a[144:147], v[80:83]
v_add_f32 v253, v125, v137
v_add_f32 v254, v126, v138
v_mfma_f32_16x16x32_bf16 v[84:87], a[216:219], a[144:147], v[84:87]
v_add_f32 v255, v127, v139
v_cvt_pk_bf16_f32 v238, v244, v245
v_mfma_f32_16x16x32_bf16 v[88:91], a[220:223], a[144:147], v[88:91]
ds_read_b128 a[144:147], v23 offset:256
v_cvt_pk_bf16_f32 v239, v246, v247
v_mfma_f32_16x16x32_bf16 v[100:103], a[220:223], a[148:151], v[100:103]
v_cvt_pk_bf16_f32 v240, v248, v249
v_cvt_pk_bf16_f32 v241, v250, v251
v_mfma_f32_16x16x32_bf16 v[96:99], a[216:219], a[148:151], v[96:99]
v_cvt_pk_bf16_f32 v242, v252, v253
v_cvt_pk_bf16_f32 v243, v254, v255
v_mfma_f32_16x16x32_bf16 v[92:95], a[212:215], a[148:151], v[92:95]
ds_read_b128 a[148:151], v24 offset:256
v_accvgpr_write_b32 a66, v238
v_accvgpr_write_b32 a67, v239
v_mfma_f32_16x16x32_bf16 v[104:107], a[212:215], a[152:155], v[104:107]
v_accvgpr_write_b32 a68, v240
v_accvgpr_write_b32 a69, v241
v_mfma_f32_16x16x32_bf16 v[108:111], a[216:219], a[152:155], v[108:111]
s_waitcnt vmcnt(6)
v_accvgpr_write_b32 a70, v242
v_accvgpr_write_b32 a71, v243
v_mfma_f32_16x16x32_bf16 v[112:115], a[220:223], a[152:155], v[112:115]
ds_read_b128 a[152:155], v25 offset:256
ds_write_b128 v27, a[0:3] offset:0
s_waitcnt lgkmcnt(5)
v_mfma_f32_16x16x32_bf16 v[32:35], a[224:227], a[128:131], v[32:35]
s_add_u32 s58, s3, 86016
v_add_f32 v244, v140, v152
v_mfma_f32_16x16x32_bf16 v[36:39], a[228:231], a[128:131], v[36:39]
buffer_load_dwordx4 a[212:215], v13, s[44:47], s58 offen sc1
v_mfma_f32_16x16x32_bf16 v[40:43], a[232:235], a[128:131], v[40:43]
ds_read_b128 a[128:131], v19 offset:320
v_mfma_f32_16x16x32_bf16 v[52:55], a[232:235], a[132:135], v[52:55]
v_add_f32 v245, v141, v153
v_add_f32 v246, v142, v154
v_mfma_f32_16x16x32_bf16 v[48:51], a[228:231], a[132:135], v[48:51]
buffer_load_dwordx4 a[216:219], v13, s[44:47], s58 offen offset:1024 sc1
v_mfma_f32_16x16x32_bf16 v[44:47], a[224:227], a[132:135], v[44:47]
ds_read_b128 a[132:135], v20 offset:320
v_mfma_f32_16x16x32_bf16 v[56:59], a[224:227], a[136:139], v[56:59]
v_add_f32 v247, v143, v155
v_add_f32 v248, v144, v156
v_mfma_f32_16x16x32_bf16 v[60:63], a[228:231], a[136:139], v[60:63]
buffer_load_dwordx4 a[220:223], v13, s[44:47], s58 offen offset:2048 sc1
v_mfma_f32_16x16x32_bf16 v[64:67], a[232:235], a[136:139], v[64:67]
ds_read_b128 a[136:139], v21 offset:320
s_waitcnt lgkmcnt(5)
v_mfma_f32_16x16x32_bf16 v[76:79], a[232:235], a[140:143], v[76:79]
s_add_u32 s59, s3, 798720
v_add_f32 v249, v145, v157
v_add_f32 v250, v146, v158
v_mfma_f32_16x16x32_bf16 v[72:75], a[228:231], a[140:143], v[72:75]
buffer_load_dwordx4 a[164:167], v13, s[44:47], s59 offen sc1
v_mfma_f32_16x16x32_bf16 v[68:71], a[224:227], a[140:143], v[68:71]
ds_read_b128 a[140:143], v22 offset:320
v_add_f32 v251, v147, v159
v_add_f32 v252, v148, v160
v_mfma_f32_16x16x32_bf16 v[80:83], a[224:227], a[144:147], v[80:83]
v_add_f32 v253, v149, v161
v_add_f32 v254, v150, v162
v_add_f32 v255, v151, v163
v_mfma_f32_16x16x32_bf16 v[84:87], a[228:231], a[144:147], v[84:87]
buffer_load_dwordx4 a[248:251], v13, s[44:47], s59 offen offset:1024 sc1
v_cvt_pk_bf16_f32 v238, v244, v245
v_mfma_f32_16x16x32_bf16 v[88:91], a[232:235], a[144:147], v[88:91]
ds_read_b128 a[144:147], v23 offset:320
v_cvt_pk_bf16_f32 v239, v246, v247
v_cvt_pk_bf16_f32 v240, v248, v249
v_mfma_f32_16x16x32_bf16 v[100:103], a[232:235], a[148:151], v[100:103]
v_cvt_pk_bf16_f32 v241, v250, v251
v_cvt_pk_bf16_f32 v242, v252, v253
v_cvt_pk_bf16_f32 v243, v254, v255
v_mfma_f32_16x16x32_bf16 v[96:99], a[228:231], a[148:151], v[96:99]
buffer_load_dwordx4 a[252:255], v13, s[44:47], s59 offen offset:2048 sc1
v_accvgpr_write_b32 a72, v238
v_mfma_f32_16x16x32_bf16 v[92:95], a[224:227], a[148:151], v[92:95]
ds_read_b128 a[148:151], v24 offset:320
v_accvgpr_write_b32 a73, v239
v_accvgpr_write_b32 a74, v240
s_waitcnt lgkmcnt(4)
v_mfma_f32_16x16x32_bf16 v[104:107], a[224:227], a[152:155], v[104:107]
v_accvgpr_write_b32 a75, v241
v_accvgpr_write_b32 a76, v242
v_mfma_f32_16x16x32_bf16 v[108:111], a[228:231], a[152:155], v[108:111]
s_waitcnt vmcnt(9)
v_accvgpr_write_b32 a77, v243
ds_write_b64 v15, a[4:5] offset:0
v_mfma_f32_16x16x32_bf16 v[112:115], a[232:235], a[152:155], v[112:115]
ds_read_b128 a[152:155], v25 offset:320
ds_write_b128 v27, a[6:9] offset:6624
v_mfma_f32_16x16x32_bf16 v[32:35], a[236:239], a[128:131], v[32:35]
s_add_u32 s58, s3, 98304
v_add_f32 v244, v164, v176
v_mfma_f32_16x16x32_bf16 v[36:39], a[240:243], a[128:131], v[36:39]
buffer_load_dwordx4 a[224:227], v13, s[44:47], s58 offen sc1
v_mfma_f32_16x16x32_bf16 v[40:43], a[244:247], a[128:131], v[40:43]
ds_read_b128 a[128:131], v19 offset:400
v_mfma_f32_16x16x32_bf16 v[52:55], a[244:247], a[132:135], v[52:55]
v_add_f32 v245, v165, v177
v_add_f32 v246, v166, v178
v_mfma_f32_16x16x32_bf16 v[48:51], a[240:243], a[132:135], v[48:51]
buffer_load_dwordx4 a[228:231], v13, s[44:47], s58 offen offset:1024 sc1
v_mfma_f32_16x16x32_bf16 v[44:47], a[236:239], a[132:135], v[44:47]
ds_read_b128 a[132:135], v20 offset:400
s_waitcnt lgkmcnt(6)
v_mfma_f32_16x16x32_bf16 v[56:59], a[236:239], a[136:139], v[56:59]
v_add_f32 v247, v167, v179
v_add_f32 v248, v168, v180
v_mfma_f32_16x16x32_bf16 v[60:63], a[240:243], a[136:139], v[60:63]
buffer_load_dwordx4 a[232:235], v13, s[44:47], s58 offen offset:2048 sc1
v_mfma_f32_16x16x32_bf16 v[64:67], a[244:247], a[136:139], v[64:67]
ds_read_b128 a[136:139], v21 offset:400
v_mfma_f32_16x16x32_bf16 v[76:79], a[244:247], a[140:143], v[76:79]
v_add_f32 v249, v169, v181
v_add_f32 v250, v170, v182
v_mfma_f32_16x16x32_bf16 v[72:75], a[240:243], a[140:143], v[72:75]
v_add_f32 v251, v171, v183
v_add_f32 v252, v172, v184
v_mfma_f32_16x16x32_bf16 v[68:71], a[236:239], a[140:143], v[68:71]
ds_read_b128 a[140:143], v22 offset:400
v_mfma_f32_16x16x32_bf16 v[80:83], a[236:239], a[144:147], v[80:83]
v_add_f32 v253, v173, v185
v_add_f32 v254, v174, v186
v_mfma_f32_16x16x32_bf16 v[84:87], a[240:243], a[144:147], v[84:87]
v_add_f32 v255, v175, v187
v_cvt_pk_bf16_f32 v238, v244, v245
v_mfma_f32_16x16x32_bf16 v[88:91], a[244:247], a[144:147], v[88:91]
ds_read_b128 a[144:147], v23 offset:400
v_cvt_pk_bf16_f32 v239, v246, v247
s_waitcnt lgkmcnt(4)
v_mfma_f32_16x16x32_bf16 v[100:103], a[244:247], a[148:151], v[100:103]
v_cvt_pk_bf16_f32 v240, v248, v249
v_cvt_pk_bf16_f32 v241, v250, v251
v_mfma_f32_16x16x32_bf16 v[96:99], a[240:243], a[148:151], v[96:99]
v_cvt_pk_bf16_f32 v242, v252, v253
v_cvt_pk_bf16_f32 v243, v254, v255
v_mfma_f32_16x16x32_bf16 v[92:95], a[236:239], a[148:151], v[92:95]
ds_read_b128 a[148:151], v24 offset:400
v_accvgpr_write_b32 a78, v238
v_accvgpr_write_b32 a79, v239
v_mfma_f32_16x16x32_bf16 v[104:107], a[236:239], a[152:155], v[104:107]
v_accvgpr_write_b32 a80, v240
v_accvgpr_write_b32 a81, v241
v_mfma_f32_16x16x32_bf16 v[108:111], a[240:243], a[152:155], v[108:111]
s_waitcnt vmcnt(9)
v_accvgpr_write_b32 a82, v242
v_accvgpr_write_b32 a83, v243
v_mfma_f32_16x16x32_bf16 v[112:115], a[244:247], a[152:155], v[112:115]
ds_read_b128 a[152:155], v25 offset:400
ds_write_b64 v15, a[10:11] offset:6624
v_mfma_f32_16x16x32_bf16 v[32:35], a[200:203], a[128:131], v[32:35]
s_add_u32 s58, s3, 110592
v_sub_f32 v244, v128, v116
v_mfma_f32_16x16x32_bf16 v[36:39], a[204:207], a[128:131], v[36:39]
buffer_load_dwordx4 a[236:239], v13, s[44:47], s58 offen sc1
v_mfma_f32_16x16x32_bf16 v[40:43], a[208:211], a[128:131], v[40:43]
ds_read_b128 a[128:131], v19 offset:464
s_waitcnt lgkmcnt(5)
v_mfma_f32_16x16x32_bf16 v[52:55], a[208:211], a[132:135], v[52:55]
v_sub_f32 v245, v129, v117
v_sub_f32 v246, v130, v118
v_mfma_f32_16x16x32_bf16 v[48:51], a[204:207], a[132:135], v[48:51]
buffer_load_dwordx4 a[240:243], v13, s[44:47], s58 offen offset:1024 sc1
v_mfma_f32_16x16x32_bf16 v[44:47], a[200:203], a[132:135], v[44:47]
ds_read_b128 a[132:135], v20 offset:464
v_mfma_f32_16x16x32_bf16 v[56:59], a[200:203], a[136:139], v[56:59]
v_sub_f32 v247, v131, v119
v_sub_f32 v248, v132, v120
v_mfma_f32_16x16x32_bf16 v[60:63], a[204:207], a[136:139], v[60:63]
buffer_load_dwordx4 a[244:247], v13, s[44:47], s58 offen offset:2048 sc1
v_mfma_f32_16x16x32_bf16 v[64:67], a[208:211], a[136:139], v[64:67]
ds_read_b128 a[136:139], v21 offset:464
v_mfma_f32_16x16x32_bf16 v[76:79], a[208:211], a[140:143], v[76:79]
s_add_u32 s59, s3, 663552
v_sub_f32 v249, v133, v121
v_mfma_f32_16x16x32_bf16 v[72:75], a[204:207], a[140:143], v[72:75]
buffer_load_dwordx4 a[0:3], v13, s[44:47], s59 offen sc1
v_mfma_f32_16x16x32_bf16 v[68:71], a[200:203], a[140:143], v[68:71]
ds_read_b128 a[140:143], v22 offset:464
v_sub_f32 v250, v134, v122
v_sub_f32 v251, v135, v123
s_waitcnt lgkmcnt(4)
v_mfma_f32_16x16x32_bf16 v[80:83], a[200:203], a[144:147], v[80:83]
v_sub_f32 v252, v136, v124
v_sub_f32 v253, v137, v125
v_sub_f32 v254, v138, v126
v_mfma_f32_16x16x32_bf16 v[84:87], a[204:207], a[144:147], v[84:87]
buffer_load_dwordx4 a[4:7], v13, s[44:47], s59 offen offset:1024 sc1
v_sub_f32 v255, v139, v127
v_mfma_f32_16x16x32_bf16 v[88:91], a[208:211], a[144:147], v[88:91]
ds_read_b128 a[144:147], v23 offset:464
v_cvt_pk_bf16_f32 v238, v244, v245
v_cvt_pk_bf16_f32 v239, v246, v247
v_mfma_f32_16x16x32_bf16 v[100:103], a[208:211], a[148:151], v[100:103]
v_cvt_pk_bf16_f32 v240, v248, v249
v_cvt_pk_bf16_f32 v241, v250, v251
v_cvt_pk_bf16_f32 v242, v252, v253
v_mfma_f32_16x16x32_bf16 v[96:99], a[204:207], a[148:151], v[96:99]
buffer_load_dwordx4 a[8:11], v13, s[44:47], s59 offen offset:2048 sc1
v_cvt_pk_bf16_f32 v243, v254, v255
v_mfma_f32_16x16x32_bf16 v[92:95], a[200:203], a[148:151], v[92:95]
ds_read_b128 a[148:151], v24 offset:464
v_accvgpr_write_b32 a108, v238
v_accvgpr_write_b32 a109, v239
v_mfma_f32_16x16x32_bf16 v[104:107], a[200:203], a[152:155], v[104:107]
v_accvgpr_write_b32 a110, v240
v_accvgpr_write_b32 a111, v241
v_mfma_f32_16x16x32_bf16 v[108:111], a[204:207], a[152:155], v[108:111]
s_waitcnt vmcnt(12)
v_accvgpr_write_b32 a112, v242
v_accvgpr_write_b32 a113, v243
v_mfma_f32_16x16x32_bf16 v[112:115], a[208:211], a[152:155], v[112:115]
ds_read_b128 a[152:155], v25 offset:464
ds_write_b128 v27, a[12:15] offset:13248
s_waitcnt lgkmcnt(4)
v_mfma_f32_16x16x32_bf16 v[32:35], a[212:215], a[128:131], v[32:35]
s_add_u32 s58, s3, 122880
v_sub_f32 v244, v152, v140
v_mfma_f32_16x16x32_bf16 v[36:39], a[216:219], a[128:131], v[36:39]
buffer_load_dwordx4 a[200:203], v13, s[44:47], s58 offen sc1
v_mfma_f32_16x16x32_bf16 v[40:43], a[220:223], a[128:131], v[40:43]
ds_read_b128 a[128:131], v19 offset:528
v_mfma_f32_16x16x32_bf16 v[52:55], a[220:223], a[132:135], v[52:55]
v_sub_f32 v245, v153, v141
v_sub_f32 v246, v154, v142
v_mfma_f32_16x16x32_bf16 v[48:51], a[216:219], a[132:135], v[48:51]
buffer_load_dwordx4 a[204:207], v13, s[44:47], s58 offen offset:1024 sc1
v_mfma_f32_16x16x32_bf16 v[44:47], a[212:215], a[132:135], v[44:47]
ds_read_b128 a[132:135], v20 offset:528
v_mfma_f32_16x16x32_bf16 v[56:59], a[212:215], a[136:139], v[56:59]
v_sub_f32 v247, v155, v143
v_sub_f32 v248, v156, v144
v_mfma_f32_16x16x32_bf16 v[60:63], a[216:219], a[136:139], v[60:63]
buffer_load_dwordx4 a[208:211], v13, s[44:47], s58 offen offset:2048 sc1
v_mfma_f32_16x16x32_bf16 v[64:67], a[220:223], a[136:139], v[64:67]
ds_read_b128 a[136:139], v21 offset:528
v_mfma_f32_16x16x32_bf16 v[76:79], a[220:223], a[140:143], v[76:79]
v_sub_f32 v249, v157, v145
v_sub_f32 v250, v158, v146
v_mfma_f32_16x16x32_bf16 v[72:75], a[216:219], a[140:143], v[72:75]
v_sub_f32 v251, v159, v147
v_sub_f32 v252, v160, v148
v_mfma_f32_16x16x32_bf16 v[68:71], a[212:215], a[140:143], v[68:71]
ds_read_b128 a[140:143], v22 offset:528
s_waitcnt lgkmcnt(4)
v_mfma_f32_16x16x32_bf16 v[80:83], a[212:215], a[144:147], v[80:83]
v_sub_f32 v253, v161, v149
v_sub_f32 v254, v162, v150
v_mfma_f32_16x16x32_bf16 v[84:87], a[216:219], a[144:147], v[84:87]
v_sub_f32 v255, v163, v151
v_cvt_pk_bf16_f32 v238, v244, v245
v_mfma_f32_16x16x32_bf16 v[88:91], a[220:223], a[144:147], v[88:91]
ds_read_b128 a[144:147], v23 offset:528
v_cvt_pk_bf16_f32 v239, v246, v247
v_cvt_pk_bf16_f32 v240, v248, v249
v_mfma_f32_16x16x32_bf16 v[100:103], a[220:223], a[148:151], v[100:103]
v_cvt_pk_bf16_f32 v241, v250, v251
v_cvt_pk_bf16_f32 v242, v252, v253
v_mfma_f32_16x16x32_bf16 v[96:99], a[216:219], a[148:151], v[96:99]
v_cvt_pk_bf16_f32 v243, v254, v255
v_accvgpr_write_b32 a114, v238
v_mfma_f32_16x16x32_bf16 v[92:95], a[212:215], a[148:151], v[92:95]
ds_read_b128 a[148:151], v24 offset:528
v_accvgpr_write_b32 a115, v239
v_accvgpr_write_b32 a116, v240
v_mfma_f32_16x16x32_bf16 v[104:107], a[212:215], a[152:155], v[104:107]
v_accvgpr_write_b32 a117, v241
v_accvgpr_write_b32 a118, v242
v_mfma_f32_16x16x32_bf16 v[108:111], a[216:219], a[152:155], v[108:111]
s_waitcnt vmcnt(9)
v_accvgpr_write_b32 a119, v243
ds_write_b64 v15, a[16:17] offset:13248
v_mfma_f32_16x16x32_bf16 v[112:115], a[220:223], a[152:155], v[112:115]
ds_read_b128 a[152:155], v25 offset:528
ds_write_b128 v27, a[18:21] offset:19872
s_waitcnt lgkmcnt(6)
v_mfma_f32_16x16x32_bf16 v[32:35], a[224:227], a[128:131], v[32:35]
s_add_u32 s58, s3, 135168
v_sub_f32 v244, v176, v164
v_mfma_f32_16x16x32_bf16 v[36:39], a[228:231], a[128:131], v[36:39]
buffer_load_dwordx4 a[212:215], v13, s[44:47], s58 offen sc1
v_mfma_f32_16x16x32_bf16 v[40:43], a[232:235], a[128:131], v[40:43]
ds_read_b128 a[128:131], v19 offset:592
v_mfma_f32_16x16x32_bf16 v[52:55], a[232:235], a[132:135], v[52:55]
v_sub_f32 v245, v177, v165
v_sub_f32 v246, v178, v166
v_mfma_f32_16x16x32_bf16 v[48:51], a[228:231], a[132:135], v[48:51]
buffer_load_dwordx4 a[216:219], v13, s[44:47], s58 offen offset:1024 sc1
v_mfma_f32_16x16x32_bf16 v[44:47], a[224:227], a[132:135], v[44:47]
ds_read_b128 a[132:135], v20 offset:592
v_mfma_f32_16x16x32_bf16 v[56:59], a[224:227], a[136:139], v[56:59]
v_sub_f32 v247, v179, v167
v_sub_f32 v248, v180, v168
v_mfma_f32_16x16x32_bf16 v[60:63], a[228:231], a[136:139], v[60:63]
buffer_load_dwordx4 a[220:223], v13, s[44:47], s58 offen offset:2048 sc1
v_mfma_f32_16x16x32_bf16 v[64:67], a[232:235], a[136:139], v[64:67]
ds_read_b128 a[136:139], v21 offset:592
s_waitcnt lgkmcnt(6)
v_mfma_f32_16x16x32_bf16 v[76:79], a[232:235], a[140:143], v[76:79]
v_sub_f32 v249, v181, v169
v_sub_f32 v250, v182, v170
v_mfma_f32_16x16x32_bf16 v[72:75], a[228:231], a[140:143], v[72:75]
v_sub_f32 v251, v183, v171
v_sub_f32 v252, v184, v172
v_mfma_f32_16x16x32_bf16 v[68:71], a[224:227], a[140:143], v[68:71]
ds_read_b128 a[140:143], v22 offset:592
v_mfma_f32_16x16x32_bf16 v[80:83], a[224:227], a[144:147], v[80:83]
v_sub_f32 v253, v185, v173
v_sub_f32 v254, v186, v174
v_mfma_f32_16x16x32_bf16 v[84:87], a[228:231], a[144:147], v[84:87]
v_sub_f32 v255, v187, v175
v_cvt_pk_bf16_f32 v238, v244, v245
v_mfma_f32_16x16x32_bf16 v[88:91], a[232:235], a[144:147], v[88:91]
ds_read_b128 a[144:147], v23 offset:592
v_cvt_pk_bf16_f32 v239, v246, v247
v_mfma_f32_16x16x32_bf16 v[100:103], a[232:235], a[148:151], v[100:103]
v_cvt_pk_bf16_f32 v240, v248, v249
v_cvt_pk_bf16_f32 v241, v250, v251
v_mfma_f32_16x16x32_bf16 v[96:99], a[228:231], a[148:151], v[96:99]
v_cvt_pk_bf16_f32 v242, v252, v253
v_cvt_pk_bf16_f32 v243, v254, v255
v_mfma_f32_16x16x32_bf16 v[92:95], a[224:227], a[148:151], v[92:95]
ds_read_b128 a[148:151], v24 offset:592
v_accvgpr_write_b32 a120, v238
v_accvgpr_write_b32 a121, v239
s_waitcnt lgkmcnt(4)
v_mfma_f32_16x16x32_bf16 v[104:107], a[224:227], a[152:155], v[104:107]
v_accvgpr_write_b32 a122, v240
v_accvgpr_write_b32 a123, v241
v_mfma_f32_16x16x32_bf16 v[108:111], a[228:231], a[152:155], v[108:111]
s_waitcnt vmcnt(9)
v_accvgpr_write_b32 a124, v242
v_accvgpr_write_b32 a125, v243
v_mfma_f32_16x16x32_bf16 v[112:115], a[232:235], a[152:155], v[112:115]
ds_read_b128 a[152:155], v25 offset:592
ds_write_b64 v15, a[22:23] offset:19872
v_mfma_f32_16x16x32_bf16 v[32:35], a[236:239], a[128:131], v[32:35]
s_add_u32 s58, s3, 147456
v_mfma_f32_16x16x32_bf16 v[36:39], a[240:243], a[128:131], v[36:39]
buffer_load_dwordx4 a[224:227], v13, s[44:47], s58 offen sc1
v_mfma_f32_16x16x32_bf16 v[40:43], a[244:247], a[128:131], v[40:43]
ds_read_b128 a[128:131], v19 offset:656
v_mfma_f32_16x16x32_bf16 v[52:55], a[244:247], a[132:135], v[52:55]
v_mfma_f32_16x16x32_bf16 v[48:51], a[240:243], a[132:135], v[48:51]
buffer_load_dwordx4 a[228:231], v13, s[44:47], s58 offen offset:1024 sc1
v_mfma_f32_16x16x32_bf16 v[44:47], a[236:239], a[132:135], v[44:47]
ds_read_b128 a[132:135], v20 offset:656
s_waitcnt lgkmcnt(5)
v_mfma_f32_16x16x32_bf16 v[56:59], a[236:239], a[136:139], v[56:59]
v_mfma_f32_16x16x32_bf16 v[60:63], a[240:243], a[136:139], v[60:63]
buffer_load_dwordx4 a[232:235], v13, s[44:47], s58 offen offset:2048 sc1
v_mfma_f32_16x16x32_bf16 v[64:67], a[244:247], a[136:139], v[64:67]
ds_read_b128 a[136:139], v21 offset:656
v_mfma_f32_16x16x32_bf16 v[76:79], a[244:247], a[140:143], v[76:79]
s_add_u32 s59, s3, 675840
v_mfma_f32_16x16x32_bf16 v[72:75], a[240:243], a[140:143], v[72:75]
buffer_load_dwordx4 a[12:15], v13, s[44:47], s59 offen sc1
v_mfma_f32_16x16x32_bf16 v[68:71], a[236:239], a[140:143], v[68:71]
ds_read_b128 a[140:143], v22 offset:656
v_mfma_f32_16x16x32_bf16 v[80:83], a[236:239], a[144:147], v[80:83]
v_mfma_f32_16x16x32_bf16 v[84:87], a[240:243], a[144:147], v[84:87]
buffer_load_dwordx4 a[16:19], v13, s[44:47], s59 offen offset:1024 sc1
v_mfma_f32_16x16x32_bf16 v[88:91], a[244:247], a[144:147], v[88:91]
ds_read_b128 a[144:147], v23 offset:656
s_waitcnt lgkmcnt(4)
v_mfma_f32_16x16x32_bf16 v[100:103], a[244:247], a[148:151], v[100:103]
v_mfma_f32_16x16x32_bf16 v[96:99], a[240:243], a[148:151], v[96:99]
buffer_load_dwordx4 a[20:23], v13, s[44:47], s59 offen offset:2048 sc1
v_mfma_f32_16x16x32_bf16 v[92:95], a[236:239], a[148:151], v[92:95]
ds_read_b128 a[148:151], v24 offset:656
v_mfma_f32_16x16x32_bf16 v[104:107], a[236:239], a[152:155], v[104:107]
ds_write_b128 v27, a[24:27] offset:26496
v_mfma_f32_16x16x32_bf16 v[108:111], a[240:243], a[152:155], v[108:111]
s_waitcnt vmcnt(9)
v_mfma_f32_16x16x32_bf16 v[112:115], a[244:247], a[152:155], v[112:115]
ds_read_b128 a[152:155], v25 offset:656
v_mfma_f32_16x16x32_bf16 v[32:35], a[200:203], a[128:131], v[32:35]
s_add_u32 s58, s3, 159744
v_mfma_f32_16x16x32_bf16 v[36:39], a[204:207], a[128:131], v[36:39]
buffer_load_dwordx4 a[236:239], v13, s[44:47], s58 offen sc1
v_mfma_f32_16x16x32_bf16 v[40:43], a[208:211], a[128:131], v[40:43]
ds_read_b128 a[128:131], v19 offset:720
s_waitcnt lgkmcnt(5)
v_mfma_f32_16x16x32_bf16 v[52:55], a[208:211], a[132:135], v[52:55]
v_mfma_f32_16x16x32_bf16 v[48:51], a[204:207], a[132:135], v[48:51]
buffer_load_dwordx4 a[240:243], v13, s[44:47], s58 offen offset:1024 sc1
v_mfma_f32_16x16x32_bf16 v[44:47], a[200:203], a[132:135], v[44:47]
ds_read_b128 a[132:135], v20 offset:720
v_mfma_f32_16x16x32_bf16 v[56:59], a[200:203], a[136:139], v[56:59]
v_mfma_f32_16x16x32_bf16 v[60:63], a[204:207], a[136:139], v[60:63]
buffer_load_dwordx4 a[244:247], v13, s[44:47], s58 offen offset:2048 sc1
v_mfma_f32_16x16x32_bf16 v[64:67], a[208:211], a[136:139], v[64:67]
ds_read_b128 a[136:139], v21 offset:720
v_mfma_f32_16x16x32_bf16 v[76:79], a[208:211], a[140:143], v[76:79]
v_mfma_f32_16x16x32_bf16 v[72:75], a[204:207], a[140:143], v[72:75]
v_mfma_f32_16x16x32_bf16 v[68:71], a[200:203], a[140:143], v[68:71]
ds_read_b128 a[140:143], v22 offset:720
s_waitcnt lgkmcnt(4)
v_mfma_f32_16x16x32_bf16 v[80:83], a[200:203], a[144:147], v[80:83]
v_mfma_f32_16x16x32_bf16 v[84:87], a[204:207], a[144:147], v[84:87]
v_mfma_f32_16x16x32_bf16 v[88:91], a[208:211], a[144:147], v[88:91]
ds_read_b128 a[144:147], v23 offset:720
v_mfma_f32_16x16x32_bf16 v[100:103], a[208:211], a[148:151], v[100:103]
v_mfma_f32_16x16x32_bf16 v[96:99], a[204:207], a[148:151], v[96:99]
ds_write_b128 v27, a[30:33] offset:33120
v_mfma_f32_16x16x32_bf16 v[92:95], a[200:203], a[148:151], v[92:95]
ds_read_b128 a[148:151], v24 offset:720
v_mfma_f32_16x16x32_bf16 v[104:107], a[200:203], a[152:155], v[104:107]
ds_write_b64 v15, a[28:29] offset:26496
v_mfma_f32_16x16x32_bf16 v[108:111], a[204:207], a[152:155], v[108:111]
s_waitcnt vmcnt(9)
v_mfma_f32_16x16x32_bf16 v[112:115], a[208:211], a[152:155], v[112:115]
ds_read_b128 a[152:155], v25 offset:720
s_waitcnt lgkmcnt(6)
v_mfma_f32_16x16x32_bf16 v[32:35], a[212:215], a[128:131], v[32:35]
s_add_u32 s58, s3, 172032
v_mfma_f32_16x16x32_bf16 v[36:39], a[216:219], a[128:131], v[36:39]
buffer_load_dwordx4 a[200:203], v13, s[44:47], s58 offen sc1
v_mfma_f32_16x16x32_bf16 v[40:43], a[220:223], a[128:131], v[40:43]
ds_read_b128 a[128:131], v19 offset:800
v_mfma_f32_16x16x32_bf16 v[52:55], a[220:223], a[132:135], v[52:55]
v_mfma_f32_16x16x32_bf16 v[48:51], a[216:219], a[132:135], v[48:51]
buffer_load_dwordx4 a[204:207], v13, s[44:47], s58 offen offset:1024 sc1
v_mfma_f32_16x16x32_bf16 v[44:47], a[212:215], a[132:135], v[44:47]
ds_read_b128 a[132:135], v20 offset:800
v_mfma_f32_16x16x32_bf16 v[56:59], a[212:215], a[136:139], v[56:59]
v_mfma_f32_16x16x32_bf16 v[60:63], a[216:219], a[136:139], v[60:63]
buffer_load_dwordx4 a[208:211], v13, s[44:47], s58 offen offset:2048 sc1
v_mfma_f32_16x16x32_bf16 v[64:67], a[220:223], a[136:139], v[64:67]
ds_read_b128 a[136:139], v21 offset:800
s_waitcnt lgkmcnt(4)
v_mfma_f32_16x16x32_bf16 v[76:79], a[220:223], a[140:143], v[76:79]
v_mfma_f32_16x16x32_bf16 v[72:75], a[216:219], a[140:143], v[72:75]
v_mfma_f32_16x16x32_bf16 v[68:71], a[212:215], a[140:143], v[68:71]
ds_read_b128 a[140:143], v22 offset:800
v_mfma_f32_16x16x32_bf16 v[80:83], a[212:215], a[144:147], v[80:83]
v_mfma_f32_16x16x32_bf16 v[84:87], a[216:219], a[144:147], v[84:87]
v_mfma_f32_16x16x32_bf16 v[88:91], a[220:223], a[144:147], v[88:91]
ds_read_b128 a[144:147], v23 offset:800
v_mfma_f32_16x16x32_bf16 v[100:103], a[220:223], a[148:151], v[100:103]
v_mfma_f32_16x16x32_bf16 v[96:99], a[216:219], a[148:151], v[96:99]
v_mfma_f32_16x16x32_bf16 v[92:95], a[212:215], a[148:151], v[92:95]
ds_read_b128 a[148:151], v24 offset:800
s_waitcnt lgkmcnt(4)
v_mfma_f32_16x16x32_bf16 v[104:107], a[212:215], a[152:155], v[104:107]
ds_write_b64 v15, a[34:35] offset:33120
v_mfma_f32_16x16x32_bf16 v[108:111], a[216:219], a[152:155], v[108:111]
s_waitcnt vmcnt(9)
v_mfma_f32_16x16x32_bf16 v[112:115], a[220:223], a[152:155], v[112:115]
ds_read_b128 a[152:155], v25 offset:800
v_mfma_f32_16x16x32_bf16 v[32:35], a[224:227], a[128:131], v[32:35]
s_add_u32 s58, s3, 184320
v_mfma_f32_16x16x32_bf16 v[36:39], a[228:231], a[128:131], v[36:39]
buffer_load_dwordx4 a[212:215], v13, s[44:47], s58 offen sc1
v_mfma_f32_16x16x32_bf16 v[40:43], a[232:235], a[128:131], v[40:43]
ds_read_b128 a[128:131], v19 offset:864
v_mfma_f32_16x16x32_bf16 v[52:55], a[232:235], a[132:135], v[52:55]
v_mfma_f32_16x16x32_bf16 v[48:51], a[228:231], a[132:135], v[48:51]
buffer_load_dwordx4 a[216:219], v13, s[44:47], s58 offen offset:1024 sc1
v_mfma_f32_16x16x32_bf16 v[44:47], a[224:227], a[132:135], v[44:47]
ds_read_b128 a[132:135], v20 offset:864
s_waitcnt lgkmcnt(5)
v_mfma_f32_16x16x32_bf16 v[56:59], a[224:227], a[136:139], v[56:59]
v_mfma_f32_16x16x32_bf16 v[60:63], a[228:231], a[136:139], v[60:63]
buffer_load_dwordx4 a[220:223], v13, s[44:47], s58 offen offset:2048 sc1
v_mfma_f32_16x16x32_bf16 v[64:67], a[232:235], a[136:139], v[64:67]
ds_read_b128 a[136:139], v21 offset:864
v_mfma_f32_16x16x32_bf16 v[76:79], a[232:235], a[140:143], v[76:79]
s_add_u32 s59, s3, 688128
v_mfma_f32_16x16x32_bf16 v[72:75], a[228:231], a[140:143], v[72:75]
buffer_load_dwordx4 a[24:27], v13, s[44:47], s59 offen sc1
v_mfma_f32_16x16x32_bf16 v[68:71], a[224:227], a[140:143], v[68:71]
ds_read_b128 a[140:143], v22 offset:864
v_mfma_f32_16x16x32_bf16 v[80:83], a[224:227], a[144:147], v[80:83]
v_mfma_f32_16x16x32_bf16 v[84:87], a[228:231], a[144:147], v[84:87]
buffer_load_dwordx4 a[28:31], v13, s[44:47], s59 offen offset:1024 sc1
v_mfma_f32_16x16x32_bf16 v[88:91], a[232:235], a[144:147], v[88:91]
ds_read_b128 a[144:147], v23 offset:864
s_waitcnt lgkmcnt(4)
v_mfma_f32_16x16x32_bf16 v[100:103], a[232:235], a[148:151], v[100:103]
v_mfma_f32_16x16x32_bf16 v[96:99], a[228:231], a[148:151], v[96:99]
buffer_load_dwordx4 a[32:35], v13, s[44:47], s59 offen offset:2048 sc1
v_mfma_f32_16x16x32_bf16 v[92:95], a[224:227], a[148:151], v[92:95]
ds_read_b128 a[148:151], v24 offset:864
v_mfma_f32_16x16x32_bf16 v[104:107], a[224:227], a[152:155], v[104:107]
ds_write_b128 v27, a[36:39] offset:39744
v_mfma_f32_16x16x32_bf16 v[108:111], a[228:231], a[152:155], v[108:111]
s_waitcnt vmcnt(9)
v_mfma_f32_16x16x32_bf16 v[112:115], a[232:235], a[152:155], v[112:115]
ds_read_b128 a[152:155], v25 offset:864
v_mfma_f32_16x16x32_bf16 v[32:35], a[236:239], a[128:131], v[32:35]
s_add_u32 s58, s3, 196608
v_mfma_f32_16x16x32_bf16 v[36:39], a[240:243], a[128:131], v[36:39]
buffer_load_dwordx4 a[224:227], v13, s[44:47], s58 offen sc1
v_mfma_f32_16x16x32_bf16 v[40:43], a[244:247], a[128:131], v[40:43]
ds_read_b128 a[128:131], v19 offset:928
s_waitcnt lgkmcnt(5)
v_mfma_f32_16x16x32_bf16 v[52:55], a[244:247], a[132:135], v[52:55]
v_mfma_f32_16x16x32_bf16 v[48:51], a[240:243], a[132:135], v[48:51]
buffer_load_dwordx4 a[228:231], v13, s[44:47], s58 offen offset:1024 sc1
v_mfma_f32_16x16x32_bf16 v[44:47], a[236:239], a[132:135], v[44:47]
ds_read_b128 a[132:135], v20 offset:928
v_mfma_f32_16x16x32_bf16 v[56:59], a[236:239], a[136:139], v[56:59]
v_mfma_f32_16x16x32_bf16 v[60:63], a[240:243], a[136:139], v[60:63]
buffer_load_dwordx4 a[232:235], v13, s[44:47], s58 offen offset:2048 sc1
v_mfma_f32_16x16x32_bf16 v[64:67], a[244:247], a[136:139], v[64:67]
ds_read_b128 a[136:139], v21 offset:928
v_mfma_f32_16x16x32_bf16 v[76:79], a[244:247], a[140:143], v[76:79]
v_mfma_f32_16x16x32_bf16 v[72:75], a[240:243], a[140:143], v[72:75]
v_mfma_f32_16x16x32_bf16 v[68:71], a[236:239], a[140:143], v[68:71]
ds_read_b128 a[140:143], v22 offset:928
s_waitcnt lgkmcnt(4)
v_mfma_f32_16x16x32_bf16 v[80:83], a[236:239], a[144:147], v[80:83]
v_mfma_f32_16x16x32_bf16 v[84:87], a[240:243], a[144:147], v[84:87]
v_mfma_f32_16x16x32_bf16 v[88:91], a[244:247], a[144:147], v[88:91]
ds_read_b128 a[144:147], v23 offset:928
v_mfma_f32_16x16x32_bf16 v[100:103], a[244:247], a[148:151], v[100:103]
v_mfma_f32_16x16x32_bf16 v[96:99], a[240:243], a[148:151], v[96:99]
v_mfma_f32_16x16x32_bf16 v[92:95], a[236:239], a[148:151], v[92:95]
ds_read_b128 a[148:151], v24 offset:928
v_mfma_f32_16x16x32_bf16 v[104:107], a[236:239], a[152:155], v[104:107]
ds_write_b64 v15, a[40:41] offset:39744
v_mfma_f32_16x16x32_bf16 v[108:111], a[240:243], a[152:155], v[108:111]
s_waitcnt vmcnt(9)
v_mfma_f32_16x16x32_bf16 v[112:115], a[244:247], a[152:155], v[112:115]
ds_read_b128 a[152:155], v25 offset:928
s_waitcnt lgkmcnt(5)
v_mfma_f32_16x16x32_bf16 v[32:35], a[200:203], a[128:131], v[32:35]
s_add_u32 s58, s3, 208896
v_mfma_f32_16x16x32_bf16 v[36:39], a[204:207], a[128:131], v[36:39]
buffer_load_dwordx4 a[236:239], v13, s[44:47], s58 offen sc1
v_mfma_f32_16x16x32_bf16 v[40:43], a[208:211], a[128:131], v[40:43]
ds_read_b128 a[128:131], v19 offset:992
v_mfma_f32_16x16x32_bf16 v[52:55], a[208:211], a[132:135], v[52:55]
v_mfma_f32_16x16x32_bf16 v[48:51], a[204:207], a[132:135], v[48:51]
buffer_load_dwordx4 a[240:243], v13, s[44:47], s58 offen offset:1024 sc1
v_mfma_f32_16x16x32_bf16 v[44:47], a[200:203], a[132:135], v[44:47]
ds_read_b128 a[132:135], v20 offset:992
v_mfma_f32_16x16x32_bf16 v[56:59], a[200:203], a[136:139], v[56:59]
v_mfma_f32_16x16x32_bf16 v[60:63], a[204:207], a[136:139], v[60:63]
buffer_load_dwordx4 a[244:247], v13, s[44:47], s58 offen offset:2048 sc1
v_mfma_f32_16x16x32_bf16 v[64:67], a[208:211], a[136:139], v[64:67]
ds_read_b128 a[136:139], v21 offset:992
s_waitcnt lgkmcnt(4)
v_mfma_f32_16x16x32_bf16 v[76:79], a[208:211], a[140:143], v[76:79]
v_mfma_f32_16x16x32_bf16 v[72:75], a[204:207], a[140:143], v[72:75]
v_mfma_f32_16x16x32_bf16 v[68:71], a[200:203], a[140:143], v[68:71]
ds_read_b128 a[140:143], v22 offset:992
v_mfma_f32_16x16x32_bf16 v[80:83], a[200:203], a[144:147], v[80:83]
v_mfma_f32_16x16x32_bf16 v[84:87], a[204:207], a[144:147], v[84:87]
v_mfma_f32_16x16x32_bf16 v[88:91], a[208:211], a[144:147], v[88:91]
ds_read_b128 a[144:147], v23 offset:992
v_mfma_f32_16x16x32_bf16 v[100:103], a[208:211], a[148:151], v[100:103]
v_mfma_f32_16x16x32_bf16 v[96:99], a[204:207], a[148:151], v[96:99]
v_mfma_f32_16x16x32_bf16 v[92:95], a[200:203], a[148:151], v[92:95]
ds_read_b128 a[148:151], v24 offset:992
s_waitcnt lgkmcnt(4)
v_mfma_f32_16x16x32_bf16 v[104:107], a[200:203], a[152:155], v[104:107]
v_mfma_f32_16x16x32_bf16 v[108:111], a[204:207], a[152:155], v[108:111]
s_waitcnt vmcnt(9)
v_mfma_f32_16x16x32_bf16 v[112:115], a[208:211], a[152:155], v[112:115]
ds_read_b128 a[152:155], v25 offset:992
v_mfma_f32_16x16x32_bf16 v[32:35], a[212:215], a[128:131], v[32:35]
s_add_u32 s58, s3, 221184
v_mfma_f32_16x16x32_bf16 v[36:39], a[216:219], a[128:131], v[36:39]
buffer_load_dwordx4 a[200:203], v13, s[44:47], s58 offen sc1
v_mfma_f32_16x16x32_bf16 v[40:43], a[220:223], a[128:131], v[40:43]
ds_read_b128 a[128:131], v19 offset:1056
v_mfma_f32_16x16x32_bf16 v[52:55], a[220:223], a[132:135], v[52:55]
v_mfma_f32_16x16x32_bf16 v[48:51], a[216:219], a[132:135], v[48:51]
buffer_load_dwordx4 a[204:207], v13, s[44:47], s58 offen offset:1024 sc1
v_mfma_f32_16x16x32_bf16 v[44:47], a[212:215], a[132:135], v[44:47]
ds_read_b128 a[132:135], v20 offset:1056
s_waitcnt lgkmcnt(4)
v_mfma_f32_16x16x32_bf16 v[56:59], a[212:215], a[136:139], v[56:59]
v_mfma_f32_16x16x32_bf16 v[60:63], a[216:219], a[136:139], v[60:63]
buffer_load_dwordx4 a[208:211], v13, s[44:47], s58 offen offset:2048 sc1
v_mfma_f32_16x16x32_bf16 v[64:67], a[220:223], a[136:139], v[64:67]
ds_read_b128 a[136:139], v21 offset:1056
v_mfma_f32_16x16x32_bf16 v[76:79], a[220:223], a[140:143], v[76:79]
v_mfma_f32_16x16x32_bf16 v[72:75], a[216:219], a[140:143], v[72:75]
v_mfma_f32_16x16x32_bf16 v[68:71], a[212:215], a[140:143], v[68:71]
ds_read_b128 a[140:143], v22 offset:1056
v_mfma_f32_16x16x32_bf16 v[80:83], a[212:215], a[144:147], v[80:83]
v_mfma_f32_16x16x32_bf16 v[84:87], a[216:219], a[144:147], v[84:87]
v_mfma_f32_16x16x32_bf16 v[88:91], a[220:223], a[144:147], v[88:91]
ds_read_b128 a[144:147], v23 offset:1056
s_waitcnt lgkmcnt(4)
v_mfma_f32_16x16x32_bf16 v[100:103], a[220:223], a[148:151], v[100:103]
v_mfma_f32_16x16x32_bf16 v[96:99], a[216:219], a[148:151], v[96:99]
v_mfma_f32_16x16x32_bf16 v[92:95], a[212:215], a[148:151], v[92:95]
ds_read_b128 a[148:151], v24 offset:1056
v_mfma_f32_16x16x32_bf16 v[104:107], a[212:215], a[152:155], v[104:107]
v_mfma_f32_16x16x32_bf16 v[108:111], a[216:219], a[152:155], v[108:111]
s_waitcnt vmcnt(6)
v_mfma_f32_16x16x32_bf16 v[112:115], a[220:223], a[152:155], v[112:115]
ds_read_b128 a[152:155], v25 offset:1056
v_mfma_f32_16x16x32_bf16 v[32:35], a[224:227], a[128:131], v[32:35]
s_add_u32 s58, s3, 233472
v_mfma_f32_16x16x32_bf16 v[36:39], a[228:231], a[128:131], v[36:39]
buffer_load_dwordx4 a[212:215], v13, s[44:47], s58 offen sc1
v_mfma_f32_16x16x32_bf16 v[40:43], a[232:235], a[128:131], v[40:43]
ds_read_b128 a[128:131], v19 offset:1120
s_waitcnt lgkmcnt(4)
v_mfma_f32_16x16x32_bf16 v[52:55], a[232:235], a[132:135], v[52:55]
v_mfma_f32_16x16x32_bf16 v[48:51], a[228:231], a[132:135], v[48:51]
buffer_load_dwordx4 a[216:219], v13, s[44:47], s58 offen offset:1024 sc1
v_mfma_f32_16x16x32_bf16 v[44:47], a[224:227], a[132:135], v[44:47]
ds_read_b128 a[132:135], v20 offset:1120
v_mfma_f32_16x16x32_bf16 v[56:59], a[224:227], a[136:139], v[56:59]
v_mfma_f32_16x16x32_bf16 v[60:63], a[228:231], a[136:139], v[60:63]
buffer_load_dwordx4 a[220:223], v13, s[44:47], s58 offen offset:2048 sc1
v_mfma_f32_16x16x32_bf16 v[64:67], a[232:235], a[136:139], v[64:67]
ds_read_b128 a[136:139], v21 offset:1120
v_mfma_f32_16x16x32_bf16 v[76:79], a[232:235], a[140:143], v[76:79]
v_mfma_f32_16x16x32_bf16 v[72:75], a[228:231], a[140:143], v[72:75]
v_mfma_f32_16x16x32_bf16 v[68:71], a[224:227], a[140:143], v[68:71]
ds_read_b128 a[140:143], v22 offset:1120
s_waitcnt lgkmcnt(4)
v_mfma_f32_16x16x32_bf16 v[80:83], a[224:227], a[144:147], v[80:83]
v_mfma_f32_16x16x32_bf16 v[84:87], a[228:231], a[144:147], v[84:87]
v_mfma_f32_16x16x32_bf16 v[88:91], a[232:235], a[144:147], v[88:91]
ds_read_b128 a[144:147], v23 offset:1120
v_mfma_f32_16x16x32_bf16 v[100:103], a[232:235], a[148:151], v[100:103]
v_mfma_f32_16x16x32_bf16 v[96:99], a[228:231], a[148:151], v[96:99]
v_mfma_f32_16x16x32_bf16 v[92:95], a[224:227], a[148:151], v[92:95]
ds_read_b128 a[148:151], v24 offset:1120
v_mfma_f32_16x16x32_bf16 v[104:107], a[224:227], a[152:155], v[104:107]
v_mfma_f32_16x16x32_bf16 v[108:111], a[228:231], a[152:155], v[108:111]
s_waitcnt vmcnt(6)
v_mfma_f32_16x16x32_bf16 v[112:115], a[232:235], a[152:155], v[112:115]
ds_read_b128 a[152:155], v25 offset:1120
s_waitcnt lgkmcnt(4)
v_mfma_f32_16x16x32_bf16 v[32:35], a[236:239], a[128:131], v[32:35]
s_add_u32 s58, s3, 245760
v_mfma_f32_16x16x32_bf16 v[36:39], a[240:243], a[128:131], v[36:39]
buffer_load_dwordx4 a[224:227], v13, s[44:47], s58 offen sc1
v_mfma_f32_16x16x32_bf16 v[40:43], a[244:247], a[128:131], v[40:43]
v_mfma_f32_16x16x32_bf16 v[52:55], a[244:247], a[132:135], v[52:55]
v_mfma_f32_16x16x32_bf16 v[48:51], a[240:243], a[132:135], v[48:51]
buffer_load_dwordx4 a[228:231], v13, s[44:47], s58 offen offset:1024 sc1
v_mfma_f32_16x16x32_bf16 v[44:47], a[236:239], a[132:135], v[44:47]
s_waitcnt lgkmcnt(0)
s_barrier
v_mfma_f32_16x16x32_bf16 v[56:59], a[236:239], a[136:139], v[56:59]
ds_read_b128 a[128:131], v19 offset:46368
v_mfma_f32_16x16x32_bf16 v[60:63], a[240:243], a[136:139], v[60:63]
buffer_load_dwordx4 a[232:235], v13, s[44:47], s58 offen offset:2048 sc1
ds_read_b128 a[132:135], v20 offset:46368
v_mfma_f32_16x16x32_bf16 v[64:67], a[244:247], a[136:139], v[64:67]
ds_read_b128 a[136:139], v21 offset:46368
v_mfma_f32_16x16x32_bf16 v[76:79], a[244:247], a[140:143], v[76:79]
v_mfma_f32_16x16x32_bf16 v[72:75], a[240:243], a[140:143], v[72:75]
v_mfma_f32_16x16x32_bf16 v[68:71], a[236:239], a[140:143], v[68:71]
ds_read_b128 a[140:143], v22 offset:46368
v_mfma_f32_16x16x32_bf16 v[80:83], a[236:239], a[144:147], v[80:83]
v_mfma_f32_16x16x32_bf16 v[84:87], a[240:243], a[144:147], v[84:87]
v_mfma_f32_16x16x32_bf16 v[88:91], a[244:247], a[144:147], v[88:91]
ds_read_b128 a[144:147], v23 offset:46368
v_mfma_f32_16x16x32_bf16 v[100:103], a[244:247], a[148:151], v[100:103]
v_mfma_f32_16x16x32_bf16 v[96:99], a[240:243], a[148:151], v[96:99]
v_mfma_f32_16x16x32_bf16 v[92:95], a[236:239], a[148:151], v[92:95]
ds_read_b128 a[148:151], v24 offset:46368
v_mfma_f32_16x16x32_bf16 v[104:107], a[236:239], a[152:155], v[104:107]
v_mfma_f32_16x16x32_bf16 v[108:111], a[240:243], a[152:155], v[108:111]
s_waitcnt vmcnt(6)
v_mfma_f32_16x16x32_bf16 v[112:115], a[244:247], a[152:155], v[112:115]
ds_read_b128 a[152:155], v2 offset:46368
s_waitcnt lgkmcnt(4)
v_mfma_f32_16x16x32_bf16 v[116:119], a[200:203], a[128:131], v[32:35]
s_add_u32 s58, s3, 258048
v_mfma_f32_16x16x32_bf16 v[120:123], a[204:207], a[128:131], v[36:39]
buffer_load_dwordx4 a[236:239], v13, s[44:47], s58 offen sc1
v_mfma_f32_16x16x32_bf16 v[124:127], a[208:211], a[128:131], v[40:43]
ds_read_b128 a[128:131], v19 offset:46432
v_mfma_f32_16x16x32_bf16 v[136:139], a[208:211], a[132:135], v[52:55]
v_mfma_f32_16x16x32_bf16 v[132:135], a[204:207], a[132:135], v[48:51]
buffer_load_dwordx4 a[240:243], v13, s[44:47], s58 offen offset:1024 sc1
v_mfma_f32_16x16x32_bf16 v[128:131], a[200:203], a[132:135], v[44:47]
ds_read_b128 a[132:135], v20 offset:46432
v_mfma_f32_16x16x32_bf16 v[140:143], a[200:203], a[136:139], v[56:59]
v_mfma_f32_16x16x32_bf16 v[144:147], a[204:207], a[136:139], v[60:63]
buffer_load_dwordx4 a[244:247], v13, s[44:47], s58 offen offset:2048 sc1
v_mfma_f32_16x16x32_bf16 v[148:151], a[208:211], a[136:139], v[64:67]
ds_read_b128 a[136:139], v21 offset:46432
s_waitcnt lgkmcnt(4)
v_mfma_f32_16x16x32_bf16 v[160:163], a[208:211], a[140:143], v[76:79]
v_mfma_f32_16x16x32_bf16 v[156:159], a[204:207], a[140:143], v[72:75]
v_mfma_f32_16x16x32_bf16 v[152:155], a[200:203], a[140:143], v[68:71]
ds_read_b128 a[140:143], v22 offset:46432
v_mfma_f32_16x16x32_bf16 v[164:167], a[200:203], a[144:147], v[80:83]
v_mfma_f32_16x16x32_bf16 v[168:171], a[204:207], a[144:147], v[84:87]
v_mfma_f32_16x16x32_bf16 v[172:175], a[208:211], a[144:147], v[88:91]
ds_read_b128 a[144:147], v23 offset:46432
v_mfma_f32_16x16x32_bf16 v[184:187], a[208:211], a[148:151], v[100:103]
v_mfma_f32_16x16x32_bf16 v[180:183], a[204:207], a[148:151], v[96:99]
v_mfma_f32_16x16x32_bf16 v[176:179], a[200:203], a[148:151], v[92:95]
ds_read_b128 a[148:151], v24 offset:46432
s_waitcnt lgkmcnt(4)
v_mfma_f32_16x16x32_bf16 v[188:191], a[200:203], a[152:155], v[104:107]
v_mfma_f32_16x16x32_bf16 v[192:195], a[204:207], a[152:155], v[108:111]
s_waitcnt vmcnt(6)
v_mfma_f32_16x16x32_bf16 v[196:199], a[208:211], a[152:155], v[112:115]
ds_read_b128 a[152:155], v2 offset:46432
v_mfma_f32_16x16x32_bf16 v[116:119], a[212:215], a[128:131], v[116:119]
s_add_u32 s58, s3, 270336
v_mfma_f32_16x16x32_bf16 v[120:123], a[216:219], a[128:131], v[120:123]
buffer_load_dwordx4 a[200:203], v13, s[44:47], s58 offen sc1
v_mfma_f32_16x16x32_bf16 v[124:127], a[220:223], a[128:131], v[124:127]
ds_read_b128 a[128:131], v19 offset:46496
v_mfma_f32_16x16x32_bf16 v[136:139], a[220:223], a[132:135], v[136:139]
v_mfma_f32_16x16x32_bf16 v[132:135], a[216:219], a[132:135], v[132:135]
buffer_load_dwordx4 a[204:207], v13, s[44:47], s58 offen offset:1024 sc1
v_mfma_f32_16x16x32_bf16 v[128:131], a[212:215], a[132:135], v[128:131]
ds_read_b128 a[132:135], v20 offset:46496
s_waitcnt lgkmcnt(4)
v_mfma_f32_16x16x32_bf16 v[140:143], a[212:215], a[136:139], v[140:143]
v_mfma_f32_16x16x32_bf16 v[144:147], a[216:219], a[136:139], v[144:147]
buffer_load_dwordx4 a[208:211], v13, s[44:47], s58 offen offset:2048 sc1
v_mfma_f32_16x16x32_bf16 v[148:151], a[220:223], a[136:139], v[148:151]
ds_read_b128 a[136:139], v21 offset:46496
v_mfma_f32_16x16x32_bf16 v[160:163], a[220:223], a[140:143], v[160:163]
v_mfma_f32_16x16x32_bf16 v[156:159], a[216:219], a[140:143], v[156:159]
v_mfma_f32_16x16x32_bf16 v[152:155], a[212:215], a[140:143], v[152:155]
ds_read_b128 a[140:143], v22 offset:46496
v_mfma_f32_16x16x32_bf16 v[164:167], a[212:215], a[144:147], v[164:167]
v_mfma_f32_16x16x32_bf16 v[168:171], a[216:219], a[144:147], v[168:171]
v_mfma_f32_16x16x32_bf16 v[172:175], a[220:223], a[144:147], v[172:175]
ds_read_b128 a[144:147], v23 offset:46496
s_waitcnt lgkmcnt(4)
v_mfma_f32_16x16x32_bf16 v[184:187], a[220:223], a[148:151], v[184:187]
v_mfma_f32_16x16x32_bf16 v[180:183], a[216:219], a[148:151], v[180:183]
v_mfma_f32_16x16x32_bf16 v[176:179], a[212:215], a[148:151], v[176:179]
ds_read_b128 a[148:151], v24 offset:46496
v_mfma_f32_16x16x32_bf16 v[188:191], a[212:215], a[152:155], v[188:191]
v_mfma_f32_16x16x32_bf16 v[192:195], a[216:219], a[152:155], v[192:195]
s_waitcnt vmcnt(6)
v_mfma_f32_16x16x32_bf16 v[196:199], a[220:223], a[152:155], v[196:199]
ds_read_b128 a[152:155], v2 offset:46496
v_mfma_f32_16x16x32_bf16 v[116:119], a[224:227], a[128:131], v[116:119]
s_add_u32 s58, s3, 282624
v_mfma_f32_16x16x32_bf16 v[120:123], a[228:231], a[128:131], v[120:123]
buffer_load_dwordx4 a[212:215], v13, s[44:47], s58 offen sc1
v_mfma_f32_16x16x32_bf16 v[124:127], a[232:235], a[128:131], v[124:127]
ds_read_b128 a[128:131], v19 offset:46560
s_waitcnt lgkmcnt(4)
v_mfma_f32_16x16x32_bf16 v[136:139], a[232:235], a[132:135], v[136:139]
v_mfma_f32_16x16x32_bf16 v[132:135], a[228:231], a[132:135], v[132:135]
buffer_load_dwordx4 a[216:219], v13, s[44:47], s58 offen offset:1024 sc1
v_mfma_f32_16x16x32_bf16 v[128:131], a[224:227], a[132:135], v[128:131]
ds_read_b128 a[132:135], v20 offset:46560
v_mfma_f32_16x16x32_bf16 v[140:143], a[224:227], a[136:139], v[140:143]
v_mfma_f32_16x16x32_bf16 v[144:147], a[228:231], a[136:139], v[144:147]
buffer_load_dwordx4 a[220:223], v13, s[44:47], s58 offen offset:2048 sc1
v_mfma_f32_16x16x32_bf16 v[148:151], a[232:235], a[136:139], v[148:151]
ds_read_b128 a[136:139], v21 offset:46560
v_mfma_f32_16x16x32_bf16 v[160:163], a[232:235], a[140:143], v[160:163]
v_mfma_f32_16x16x32_bf16 v[156:159], a[228:231], a[140:143], v[156:159]
v_mfma_f32_16x16x32_bf16 v[152:155], a[224:227], a[140:143], v[152:155]
ds_read_b128 a[140:143], v22 offset:46560
s_waitcnt lgkmcnt(4)
v_mfma_f32_16x16x32_bf16 v[164:167], a[224:227], a[144:147], v[164:167]
v_mfma_f32_16x16x32_bf16 v[168:171], a[228:231], a[144:147], v[168:171]
v_mfma_f32_16x16x32_bf16 v[172:175], a[232:235], a[144:147], v[172:175]
ds_read_b128 a[144:147], v23 offset:46560
v_mfma_f32_16x16x32_bf16 v[184:187], a[232:235], a[148:151], v[184:187]
v_mfma_f32_16x16x32_bf16 v[180:183], a[228:231], a[148:151], v[180:183]
v_mfma_f32_16x16x32_bf16 v[176:179], a[224:227], a[148:151], v[176:179]
ds_read_b128 a[148:151], v24 offset:46560
v_mfma_f32_16x16x32_bf16 v[188:191], a[224:227], a[152:155], v[188:191]
v_mfma_f32_16x16x32_bf16 v[192:195], a[228:231], a[152:155], v[192:195]
s_waitcnt vmcnt(6)
v_mfma_f32_16x16x32_bf16 v[196:199], a[232:235], a[152:155], v[196:199]
ds_read_b128 a[152:155], v2 offset:46560
s_waitcnt lgkmcnt(4)
v_mfma_f32_16x16x32_bf16 v[116:119], a[236:239], a[128:131], v[116:119]
s_add_u32 s58, s3, 294912
v_mfma_f32_16x16x32_bf16 v[120:123], a[240:243], a[128:131], v[120:123]
buffer_load_dwordx4 a[224:227], v13, s[44:47], s58 offen sc1
v_mfma_f32_16x16x32_bf16 v[124:127], a[244:247], a[128:131], v[124:127]
ds_read_b128 a[128:131], v19 offset:46624
v_mfma_f32_16x16x32_bf16 v[136:139], a[244:247], a[132:135], v[136:139]
v_mfma_f32_16x16x32_bf16 v[132:135], a[240:243], a[132:135], v[132:135]
buffer_load_dwordx4 a[228:231], v13, s[44:47], s58 offen offset:1024 sc1
v_mfma_f32_16x16x32_bf16 v[128:131], a[236:239], a[132:135], v[128:131]
ds_read_b128 a[132:135], v20 offset:46624
v_mfma_f32_16x16x32_bf16 v[140:143], a[236:239], a[136:139], v[140:143]
v_mfma_f32_16x16x32_bf16 v[144:147], a[240:243], a[136:139], v[144:147]
buffer_load_dwordx4 a[232:235], v13, s[44:47], s58 offen offset:2048 sc1
v_mfma_f32_16x16x32_bf16 v[148:151], a[244:247], a[136:139], v[148:151]
ds_read_b128 a[136:139], v21 offset:46624
s_waitcnt lgkmcnt(4)
v_mfma_f32_16x16x32_bf16 v[160:163], a[244:247], a[140:143], v[160:163]
v_mfma_f32_16x16x32_bf16 v[156:159], a[240:243], a[140:143], v[156:159]
v_mfma_f32_16x16x32_bf16 v[152:155], a[236:239], a[140:143], v[152:155]
ds_read_b128 a[140:143], v22 offset:46624
v_mfma_f32_16x16x32_bf16 v[164:167], a[236:239], a[144:147], v[164:167]
v_mfma_f32_16x16x32_bf16 v[168:171], a[240:243], a[144:147], v[168:171]
v_mfma_f32_16x16x32_bf16 v[172:175], a[244:247], a[144:147], v[172:175]
ds_read_b128 a[144:147], v23 offset:46624
v_mfma_f32_16x16x32_bf16 v[184:187], a[244:247], a[148:151], v[184:187]
v_mfma_f32_16x16x32_bf16 v[180:183], a[240:243], a[148:151], v[180:183]
v_mfma_f32_16x16x32_bf16 v[176:179], a[236:239], a[148:151], v[176:179]
ds_read_b128 a[148:151], v24 offset:46624
s_waitcnt lgkmcnt(4)
v_mfma_f32_16x16x32_bf16 v[188:191], a[236:239], a[152:155], v[188:191]
ds_write_b128 v26, a[42:45] offset:0
v_mfma_f32_16x16x32_bf16 v[192:195], a[240:243], a[152:155], v[192:195]
s_waitcnt vmcnt(6)
v_mfma_f32_16x16x32_bf16 v[196:199], a[244:247], a[152:155], v[196:199]
ds_read_b128 a[152:155], v2 offset:46624
v_mfma_f32_16x16x32_bf16 v[116:119], a[200:203], a[128:131], v[116:119]
s_add_u32 s58, s3, 307200
v_mfma_f32_16x16x32_bf16 v[120:123], a[204:207], a[128:131], v[120:123]
buffer_load_dwordx4 a[236:239], v13, s[44:47], s58 offen sc1
v_mfma_f32_16x16x32_bf16 v[124:127], a[208:211], a[128:131], v[124:127]
ds_read_b128 a[128:131], v19 offset:46688
v_mfma_f32_16x16x32_bf16 v[136:139], a[208:211], a[132:135], v[136:139]
v_mfma_f32_16x16x32_bf16 v[132:135], a[204:207], a[132:135], v[132:135]
buffer_load_dwordx4 a[240:243], v13, s[44:47], s58 offen offset:1024 sc1
v_mfma_f32_16x16x32_bf16 v[128:131], a[200:203], a[132:135], v[128:131]
ds_read_b128 a[132:135], v20 offset:46688
s_waitcnt lgkmcnt(5)
v_mfma_f32_16x16x32_bf16 v[140:143], a[200:203], a[136:139], v[140:143]
v_mfma_f32_16x16x32_bf16 v[144:147], a[204:207], a[136:139], v[144:147]
buffer_load_dwordx4 a[244:247], v13, s[44:47], s58 offen offset:2048 sc1
v_mfma_f32_16x16x32_bf16 v[148:151], a[208:211], a[136:139], v[148:151]
ds_read_b128 a[136:139], v21 offset:46688
v_mfma_f32_16x16x32_bf16 v[160:163], a[208:211], a[140:143], v[160:163]
v_mfma_f32_16x16x32_bf16 v[156:159], a[204:207], a[140:143], v[156:159]
v_mfma_f32_16x16x32_bf16 v[152:155], a[200:203], a[140:143], v[152:155]
ds_read_b128 a[140:143], v22 offset:46688
v_mfma_f32_16x16x32_bf16 v[164:167], a[200:203], a[144:147], v[164:167]
v_mfma_f32_16x16x32_bf16 v[168:171], a[204:207], a[144:147], v[168:171]
v_mfma_f32_16x16x32_bf16 v[172:175], a[208:211], a[144:147], v[172:175]
ds_read_b128 a[144:147], v23 offset:46688
s_waitcnt lgkmcnt(4)
v_mfma_f32_16x16x32_bf16 v[184:187], a[208:211], a[148:151], v[184:187]
v_mfma_f32_16x16x32_bf16 v[180:183], a[204:207], a[148:151], v[180:183]
ds_write_b128 v26, a[48:51] offset:6624
v_mfma_f32_16x16x32_bf16 v[176:179], a[200:203], a[148:151], v[176:179]
ds_read_b128 a[148:151], v24 offset:46688
v_mfma_f32_16x16x32_bf16 v[188:191], a[200:203], a[152:155], v[188:191]
ds_write_b64 v14, a[46:47] offset:0
v_mfma_f32_16x16x32_bf16 v[192:195], a[204:207], a[152:155], v[192:195]
s_waitcnt vmcnt(6)
v_mfma_f32_16x16x32_bf16 v[196:199], a[208:211], a[152:155], v[196:199]
ds_read_b128 a[152:155], v2 offset:46688
v_mfma_f32_16x16x32_bf16 v[116:119], a[212:215], a[128:131], v[116:119]
s_add_u32 s58, s3, 319488
v_mfma_f32_16x16x32_bf16 v[120:123], a[216:219], a[128:131], v[120:123]
buffer_load_dwordx4 a[200:203], v13, s[44:47], s58 offen sc1
v_mfma_f32_16x16x32_bf16 v[124:127], a[220:223], a[128:131], v[124:127]
ds_read_b128 a[128:131], v19 offset:46768
s_waitcnt lgkmcnt(6)
v_mfma_f32_16x16x32_bf16 v[136:139], a[220:223], a[132:135], v[136:139]
v_mfma_f32_16x16x32_bf16 v[132:135], a[216:219], a[132:135], v[132:135]
buffer_load_dwordx4 a[204:207], v13, s[44:47], s58 offen offset:1024 sc1
v_mfma_f32_16x16x32_bf16 v[128:131], a[212:215], a[132:135], v[128:131]
ds_read_b128 a[132:135], v20 offset:46768
v_mfma_f32_16x16x32_bf16 v[140:143], a[212:215], a[136:139], v[140:143]
v_mfma_f32_16x16x32_bf16 v[144:147], a[216:219], a[136:139], v[144:147]
buffer_load_dwordx4 a[208:211], v13, s[44:47], s58 offen offset:2048 sc1
v_mfma_f32_16x16x32_bf16 v[148:151], a[220:223], a[136:139], v[148:151]
ds_read_b128 a[136:139], v21 offset:46768
v_mfma_f32_16x16x32_bf16 v[160:163], a[220:223], a[140:143], v[160:163]
s_add_u32 s59, s3, 700416
v_mfma_f32_16x16x32_bf16 v[156:159], a[216:219], a[140:143], v[156:159]
buffer_load_dwordx4 a[36:39], v13, s[44:47], s59 offen sc1
v_mfma_f32_16x16x32_bf16 v[152:155], a[212:215], a[140:143], v[152:155]
ds_read_b128 a[140:143], v22 offset:46768
s_waitcnt lgkmcnt(4)
v_mfma_f32_16x16x32_bf16 v[164:167], a[212:215], a[144:147], v[164:167]
v_mfma_f32_16x16x32_bf16 v[168:171], a[216:219], a[144:147], v[168:171]
buffer_load_dwordx4 a[40:43], v13, s[44:47], s59 offen offset:1024 sc1
v_mfma_f32_16x16x32_bf16 v[172:175], a[220:223], a[144:147], v[172:175]
ds_read_b128 a[144:147], v23 offset:46768
v_mfma_f32_16x16x32_bf16 v[184:187], a[220:223], a[148:151], v[184:187]
v_mfma_f32_16x16x32_bf16 v[180:183], a[216:219], a[148:151], v[180:183]
buffer_load_dwordx4 a[44:47], v13, s[44:47], s59 offen offset:2048 sc1
v_mfma_f32_16x16x32_bf16 v[176:179], a[212:215], a[148:151], v[176:179]
ds_read_b128 a[148:151], v24 offset:46768
v_mfma_f32_16x16x32_bf16 v[188:191], a[212:215], a[152:155], v[188:191]
ds_write_b64 v14, a[52:53] offset:6624
v_mfma_f32_16x16x32_bf16 v[192:195], a[216:219], a[152:155], v[192:195]
s_waitcnt vmcnt(9)
v_mfma_f32_16x16x32_bf16 v[196:199], a[220:223], a[152:155], v[196:199]
ds_read_b128 a[152:155], v2 offset:46768
s_waitcnt lgkmcnt(5)
v_mfma_f32_16x16x32_bf16 v[116:119], a[224:227], a[128:131], v[116:119]
s_add_u32 s58, s3, 331776
v_mfma_f32_16x16x32_bf16 v[120:123], a[228:231], a[128:131], v[120:123]
buffer_load_dwordx4 a[212:215], v13, s[44:47], s58 offen sc1
v_mfma_f32_16x16x32_bf16 v[124:127], a[232:235], a[128:131], v[124:127]
ds_read_b128 a[128:131], v19 offset:46832
v_mfma_f32_16x16x32_bf16 v[136:139], a[232:235], a[132:135], v[136:139]
v_mfma_f32_16x16x32_bf16 v[132:135], a[228:231], a[132:135], v[132:135]
buffer_load_dwordx4 a[216:219], v13, s[44:47], s58 offen offset:1024 sc1
v_mfma_f32_16x16x32_bf16 v[128:131], a[224:227], a[132:135], v[128:131]
ds_read_b128 a[132:135], v20 offset:46832
v_mfma_f32_16x16x32_bf16 v[140:143], a[224:227], a[136:139], v[140:143]
v_mfma_f32_16x16x32_bf16 v[144:147], a[228:231], a[136:139], v[144:147]
buffer_load_dwordx4 a[220:223], v13, s[44:47], s58 offen offset:2048 sc1
v_mfma_f32_16x16x32_bf16 v[148:151], a[232:235], a[136:139], v[148:151]
ds_read_b128 a[136:139], v21 offset:46832
s_waitcnt lgkmcnt(4)
v_mfma_f32_16x16x32_bf16 v[160:163], a[232:235], a[140:143], v[160:163]
v_mfma_f32_16x16x32_bf16 v[156:159], a[228:231], a[140:143], v[156:159]
v_mfma_f32_16x16x32_bf16 v[152:155], a[224:227], a[140:143], v[152:155]
ds_read_b128 a[140:143], v22 offset:46832
v_mfma_f32_16x16x32_bf16 v[164:167], a[224:227], a[144:147], v[164:167]
v_mfma_f32_16x16x32_bf16 v[168:171], a[228:231], a[144:147], v[168:171]
v_mfma_f32_16x16x32_bf16 v[172:175], a[232:235], a[144:147], v[172:175]
ds_read_b128 a[144:147], v23 offset:46832
v_mfma_f32_16x16x32_bf16 v[184:187], a[232:235], a[148:151], v[184:187]
v_mfma_f32_16x16x32_bf16 v[180:183], a[228:231], a[148:151], v[180:183]
v_mfma_f32_16x16x32_bf16 v[176:179], a[224:227], a[148:151], v[176:179]
ds_read_b128 a[148:151], v24 offset:46832
s_waitcnt lgkmcnt(4)
v_mfma_f32_16x16x32_bf16 v[188:191], a[224:227], a[152:155], v[188:191]
ds_write_b128 v26, a[54:57] offset:13248
v_mfma_f32_16x16x32_bf16 v[192:195], a[228:231], a[152:155], v[192:195]
s_waitcnt vmcnt(9)
v_mfma_f32_16x16x32_bf16 v[196:199], a[232:235], a[152:155], v[196:199]
ds_read_b128 a[152:155], v2 offset:46832
v_mfma_f32_16x16x32_bf16 v[116:119], a[236:239], a[128:131], v[116:119]
s_add_u32 s58, s3, 344064
v_mfma_f32_16x16x32_bf16 v[120:123], a[240:243], a[128:131], v[120:123]
buffer_load_dwordx4 a[224:227], v13, s[44:47], s58 offen sc1
v_mfma_f32_16x16x32_bf16 v[124:127], a[244:247], a[128:131], v[124:127]
ds_read_b128 a[128:131], v19 offset:46896
v_mfma_f32_16x16x32_bf16 v[136:139], a[244:247], a[132:135], v[136:139]
v_mfma_f32_16x16x32_bf16 v[132:135], a[240:243], a[132:135], v[132:135]
buffer_load_dwordx4 a[228:231], v13, s[44:47], s58 offen offset:1024 sc1
v_mfma_f32_16x16x32_bf16 v[128:131], a[236:239], a[132:135], v[128:131]
ds_read_b128 a[132:135], v20 offset:46896
s_waitcnt lgkmcnt(5)
v_mfma_f32_16x16x32_bf16 v[140:143], a[236:239], a[136:139], v[140:143]
v_mfma_f32_16x16x32_bf16 v[144:147], a[240:243], a[136:139], v[144:147]
buffer_load_dwordx4 a[232:235], v13, s[44:47], s58 offen offset:2048 sc1
v_mfma_f32_16x16x32_bf16 v[148:151], a[244:247], a[136:139], v[148:151]
ds_read_b128 a[136:139], v21 offset:46896
v_mfma_f32_16x16x32_bf16 v[160:163], a[244:247], a[140:143], v[160:163]
v_mfma_f32_16x16x32_bf16 v[156:159], a[240:243], a[140:143], v[156:159]
v_mfma_f32_16x16x32_bf16 v[152:155], a[236:239], a[140:143], v[152:155]
ds_read_b128 a[140:143], v22 offset:46896
v_mfma_f32_16x16x32_bf16 v[164:167], a[236:239], a[144:147], v[164:167]
v_mfma_f32_16x16x32_bf16 v[168:171], a[240:243], a[144:147], v[168:171]
v_mfma_f32_16x16x32_bf16 v[172:175], a[244:247], a[144:147], v[172:175]
ds_read_b128 a[144:147], v23 offset:46896
s_waitcnt lgkmcnt(4)
v_mfma_f32_16x16x32_bf16 v[184:187], a[244:247], a[148:151], v[184:187]
v_mfma_f32_16x16x32_bf16 v[180:183], a[240:243], a[148:151], v[180:183]
ds_write_b128 v26, a[60:63] offset:19872
v_mfma_f32_16x16x32_bf16 v[176:179], a[236:239], a[148:151], v[176:179]
ds_read_b128 a[148:151], v24 offset:46896
v_mfma_f32_16x16x32_bf16 v[188:191], a[236:239], a[152:155], v[188:191]
ds_write_b64 v14, a[58:59] offset:13248
v_mfma_f32_16x16x32_bf16 v[192:195], a[240:243], a[152:155], v[192:195]
s_waitcnt vmcnt(9)
v_mfma_f32_16x16x32_bf16 v[196:199], a[244:247], a[152:155], v[196:199]
ds_read_b128 a[152:155], v2 offset:46896
v_mfma_f32_16x16x32_bf16 v[116:119], a[200:203], a[128:131], v[116:119]
s_add_u32 s58, s3, 356352
v_mfma_f32_16x16x32_bf16 v[120:123], a[204:207], a[128:131], v[120:123]
buffer_load_dwordx4 a[236:239], v13, s[44:47], s58 offen sc1
v_mfma_f32_16x16x32_bf16 v[124:127], a[208:211], a[128:131], v[124:127]
ds_read_b128 a[128:131], v19 offset:46960
s_waitcnt lgkmcnt(6)
v_mfma_f32_16x16x32_bf16 v[136:139], a[208:211], a[132:135], v[136:139]
v_mfma_f32_16x16x32_bf16 v[132:135], a[204:207], a[132:135], v[132:135]
buffer_load_dwordx4 a[240:243], v13, s[44:47], s58 offen offset:1024 sc1
v_mfma_f32_16x16x32_bf16 v[128:131], a[200:203], a[132:135], v[128:131]
ds_read_b128 a[132:135], v20 offset:46960
v_mfma_f32_16x16x32_bf16 v[140:143], a[200:203], a[136:139], v[140:143]
v_mfma_f32_16x16x32_bf16 v[144:147], a[204:207], a[136:139], v[144:147]
buffer_load_dwordx4 a[244:247], v13, s[44:47], s58 offen offset:2048 sc1
v_mfma_f32_16x16x32_bf16 v[148:151], a[208:211], a[136:139], v[148:151]
ds_read_b128 a[136:139], v21 offset:46960
v_mfma_f32_16x16x32_bf16 v[160:163], a[208:211], a[140:143], v[160:163]
s_add_u32 s59, s3, 712704
v_mfma_f32_16x16x32_bf16 v[156:159], a[204:207], a[140:143], v[156:159]
buffer_load_dwordx4 a[48:51], v13, s[44:47], s59 offen sc1
v_mfma_f32_16x16x32_bf16 v[152:155], a[200:203], a[140:143], v[152:155]
ds_read_b128 a[140:143], v22 offset:46960
s_waitcnt lgkmcnt(4)
v_mfma_f32_16x16x32_bf16 v[164:167], a[200:203], a[144:147], v[164:167]
v_mfma_f32_16x16x32_bf16 v[168:171], a[204:207], a[144:147], v[168:171]
buffer_load_dwordx4 a[52:55], v13, s[44:47], s59 offen offset:1024 sc1
v_mfma_f32_16x16x32_bf16 v[172:175], a[208:211], a[144:147], v[172:175]
ds_read_b128 a[144:147], v23 offset:46960
v_mfma_f32_16x16x32_bf16 v[184:187], a[208:211], a[148:151], v[184:187]
v_mfma_f32_16x16x32_bf16 v[180:183], a[204:207], a[148:151], v[180:183]
buffer_load_dwordx4 a[56:59], v13, s[44:47], s59 offen offset:2048 sc1
v_mfma_f32_16x16x32_bf16 v[176:179], a[200:203], a[148:151], v[176:179]
ds_read_b128 a[148:151], v24 offset:46960
v_mfma_f32_16x16x32_bf16 v[188:191], a[200:203], a[152:155], v[188:191]
ds_write_b64 v14, a[64:65] offset:19872
v_mfma_f32_16x16x32_bf16 v[192:195], a[204:207], a[152:155], v[192:195]
s_waitcnt vmcnt(9)
v_mfma_f32_16x16x32_bf16 v[196:199], a[208:211], a[152:155], v[196:199]
ds_read_b128 a[152:155], v2 offset:46960
s_waitcnt lgkmcnt(5)
v_mfma_f32_16x16x32_bf16 v[116:119], a[212:215], a[128:131], v[116:119]
s_add_u32 s58, s3, 368640
v_mfma_f32_16x16x32_bf16 v[120:123], a[216:219], a[128:131], v[120:123]
buffer_load_dwordx4 a[200:203], v13, s[44:47], s58 offen sc1
v_mfma_f32_16x16x32_bf16 v[124:127], a[220:223], a[128:131], v[124:127]
ds_read_b128 a[128:131], v19 offset:47024
v_mfma_f32_16x16x32_bf16 v[136:139], a[220:223], a[132:135], v[136:139]
v_mfma_f32_16x16x32_bf16 v[132:135], a[216:219], a[132:135], v[132:135]
buffer_load_dwordx4 a[204:207], v13, s[44:47], s58 offen offset:1024 sc1
v_mfma_f32_16x16x32_bf16 v[128:131], a[212:215], a[132:135], v[128:131]
ds_read_b128 a[132:135], v20 offset:47024
v_mfma_f32_16x16x32_bf16 v[140:143], a[212:215], a[136:139], v[140:143]
v_mfma_f32_16x16x32_bf16 v[144:147], a[216:219], a[136:139], v[144:147]
buffer_load_dwordx4 a[208:211], v13, s[44:47], s58 offen offset:2048 sc1
v_mfma_f32_16x16x32_bf16 v[148:151], a[220:223], a[136:139], v[148:151]
ds_read_b128 a[136:139], v21 offset:47024
s_waitcnt lgkmcnt(4)
v_mfma_f32_16x16x32_bf16 v[160:163], a[220:223], a[140:143], v[160:163]
v_mfma_f32_16x16x32_bf16 v[156:159], a[216:219], a[140:143], v[156:159]
v_mfma_f32_16x16x32_bf16 v[152:155], a[212:215], a[140:143], v[152:155]
ds_read_b128 a[140:143], v22 offset:47024
v_mfma_f32_16x16x32_bf16 v[164:167], a[212:215], a[144:147], v[164:167]
v_mfma_f32_16x16x32_bf16 v[168:171], a[216:219], a[144:147], v[168:171]
v_mfma_f32_16x16x32_bf16 v[172:175], a[220:223], a[144:147], v[172:175]
ds_read_b128 a[144:147], v23 offset:47024
v_mfma_f32_16x16x32_bf16 v[184:187], a[220:223], a[148:151], v[184:187]
v_mfma_f32_16x16x32_bf16 v[180:183], a[216:219], a[148:151], v[180:183]
v_mfma_f32_16x16x32_bf16 v[176:179], a[212:215], a[148:151], v[176:179]
ds_read_b128 a[148:151], v24 offset:47024
s_waitcnt lgkmcnt(4)
v_mfma_f32_16x16x32_bf16 v[188:191], a[212:215], a[152:155], v[188:191]
ds_write_b128 v26, a[66:69] offset:26496
v_mfma_f32_16x16x32_bf16 v[192:195], a[216:219], a[152:155], v[192:195]
s_waitcnt vmcnt(9)
v_mfma_f32_16x16x32_bf16 v[196:199], a[220:223], a[152:155], v[196:199]
ds_read_b128 a[152:155], v2 offset:47024
v_mfma_f32_16x16x32_bf16 v[116:119], a[224:227], a[128:131], v[116:119]
s_add_u32 s58, s3, 380928
v_mfma_f32_16x16x32_bf16 v[120:123], a[228:231], a[128:131], v[120:123]
buffer_load_dwordx4 a[212:215], v13, s[44:47], s58 offen sc1
v_mfma_f32_16x16x32_bf16 v[124:127], a[232:235], a[128:131], v[124:127]
ds_read_b128 a[128:131], v19 offset:47088
v_mfma_f32_16x16x32_bf16 v[136:139], a[232:235], a[132:135], v[136:139]
v_mfma_f32_16x16x32_bf16 v[132:135], a[228:231], a[132:135], v[132:135]
buffer_load_dwordx4 a[216:219], v13, s[44:47], s58 offen offset:1024 sc1
v_mfma_f32_16x16x32_bf16 v[128:131], a[224:227], a[132:135], v[128:131]
ds_read_b128 a[132:135], v20 offset:47088
s_waitcnt lgkmcnt(5)
v_mfma_f32_16x16x32_bf16 v[140:143], a[224:227], a[136:139], v[140:143]
v_mfma_f32_16x16x32_bf16 v[144:147], a[228:231], a[136:139], v[144:147]
buffer_load_dwordx4 a[220:223], v13, s[44:47], s58 offen offset:2048 sc1
v_mfma_f32_16x16x32_bf16 v[148:151], a[232:235], a[136:139], v[148:151]
ds_read_b128 a[136:139], v21 offset:47088
v_mfma_f32_16x16x32_bf16 v[160:163], a[232:235], a[140:143], v[160:163]
v_mfma_f32_16x16x32_bf16 v[156:159], a[228:231], a[140:143], v[156:159]
v_mfma_f32_16x16x32_bf16 v[152:155], a[224:227], a[140:143], v[152:155]
ds_read_b128 a[140:143], v22 offset:47088
v_mfma_f32_16x16x32_bf16 v[164:167], a[224:227], a[144:147], v[164:167]
v_mfma_f32_16x16x32_bf16 v[168:171], a[228:231], a[144:147], v[168:171]
v_mfma_f32_16x16x32_bf16 v[172:175], a[232:235], a[144:147], v[172:175]
ds_read_b128 a[144:147], v23 offset:47088
s_waitcnt lgkmcnt(4)
v_mfma_f32_16x16x32_bf16 v[184:187], a[232:235], a[148:151], v[184:187]
v_mfma_f32_16x16x32_bf16 v[180:183], a[228:231], a[148:151], v[180:183]
ds_write_b128 v26, a[72:75] offset:33120
v_mfma_f32_16x16x32_bf16 v[176:179], a[224:227], a[148:151], v[176:179]
ds_read_b128 a[148:151], v24 offset:47088
v_mfma_f32_16x16x32_bf16 v[188:191], a[224:227], a[152:155], v[188:191]
ds_write_b64 v14, a[70:71] offset:26496
v_mfma_f32_16x16x32_bf16 v[192:195], a[228:231], a[152:155], v[192:195]
s_waitcnt vmcnt(9)
v_mfma_f32_16x16x32_bf16 v[196:199], a[232:235], a[152:155], v[196:199]
ds_read_b128 a[152:155], v2 offset:47088
v_mfma_f32_16x16x32_bf16 v[116:119], a[236:239], a[128:131], v[116:119]
s_add_u32 s58, s3, 393216
v_mfma_f32_16x16x32_bf16 v[120:123], a[240:243], a[128:131], v[120:123]
buffer_load_dwordx4 a[224:227], v13, s[44:47], s58 offen sc1
v_mfma_f32_16x16x32_bf16 v[124:127], a[244:247], a[128:131], v[124:127]
ds_read_b128 a[128:131], v19 offset:47168
s_waitcnt lgkmcnt(6)
v_mfma_f32_16x16x32_bf16 v[136:139], a[244:247], a[132:135], v[136:139]
v_mfma_f32_16x16x32_bf16 v[132:135], a[240:243], a[132:135], v[132:135]
buffer_load_dwordx4 a[228:231], v13, s[44:47], s58 offen offset:1024 sc1
v_mfma_f32_16x16x32_bf16 v[128:131], a[236:239], a[132:135], v[128:131]
ds_read_b128 a[132:135], v20 offset:47168
v_mfma_f32_16x16x32_bf16 v[140:143], a[236:239], a[136:139], v[140:143]
v_mfma_f32_16x16x32_bf16 v[144:147], a[240:243], a[136:139], v[144:147]
buffer_load_dwordx4 a[232:235], v13, s[44:47], s58 offen offset:2048 sc1
v_mfma_f32_16x16x32_bf16 v[148:151], a[244:247], a[136:139], v[148:151]
ds_read_b128 a[136:139], v21 offset:47168
v_mfma_f32_16x16x32_bf16 v[160:163], a[244:247], a[140:143], v[160:163]
s_add_u32 s59, s3, 724992
v_mfma_f32_16x16x32_bf16 v[156:159], a[240:243], a[140:143], v[156:159]
buffer_load_dwordx4 a[60:63], v13, s[44:47], s59 offen sc1
v_mfma_f32_16x16x32_bf16 v[152:155], a[236:239], a[140:143], v[152:155]
ds_read_b128 a[140:143], v22 offset:47168
s_waitcnt lgkmcnt(4)
v_mfma_f32_16x16x32_bf16 v[164:167], a[236:239], a[144:147], v[164:167]
v_mfma_f32_16x16x32_bf16 v[168:171], a[240:243], a[144:147], v[168:171]
buffer_load_dwordx4 a[64:67], v13, s[44:47], s59 offen offset:1024 sc1
v_mfma_f32_16x16x32_bf16 v[172:175], a[244:247], a[144:147], v[172:175]
ds_read_b128 a[144:147], v23 offset:47168
v_mfma_f32_16x16x32_bf16 v[184:187], a[244:247], a[148:151], v[184:187]
v_mfma_f32_16x16x32_bf16 v[180:183], a[240:243], a[148:151], v[180:183]
buffer_load_dwordx4 a[68:71], v13, s[44:47], s59 offen offset:2048 sc1
v_mfma_f32_16x16x32_bf16 v[176:179], a[236:239], a[148:151], v[176:179]
ds_read_b128 a[148:151], v24 offset:47168
v_mfma_f32_16x16x32_bf16 v[188:191], a[236:239], a[152:155], v[188:191]
ds_write_b64 v14, a[76:77] offset:33120
v_mfma_f32_16x16x32_bf16 v[192:195], a[240:243], a[152:155], v[192:195]
s_waitcnt vmcnt(9)
v_mfma_f32_16x16x32_bf16 v[196:199], a[244:247], a[152:155], v[196:199]
ds_read_b128 a[152:155], v2 offset:47168
s_waitcnt lgkmcnt(5)
v_mfma_f32_16x16x32_bf16 v[116:119], a[200:203], a[128:131], v[116:119]
s_add_u32 s58, s3, 405504
v_mfma_f32_16x16x32_bf16 v[120:123], a[204:207], a[128:131], v[120:123]
buffer_load_dwordx4 a[236:239], v13, s[44:47], s58 offen sc1
v_mfma_f32_16x16x32_bf16 v[124:127], a[208:211], a[128:131], v[124:127]
ds_read_b128 a[128:131], v19 offset:47232
v_mfma_f32_16x16x32_bf16 v[136:139], a[208:211], a[132:135], v[136:139]
v_mfma_f32_16x16x32_bf16 v[132:135], a[204:207], a[132:135], v[132:135]
buffer_load_dwordx4 a[240:243], v13, s[44:47], s58 offen offset:1024 sc1
v_mfma_f32_16x16x32_bf16 v[128:131], a[200:203], a[132:135], v[128:131]
ds_read_b128 a[132:135], v20 offset:47232
v_mfma_f32_16x16x32_bf16 v[140:143], a[200:203], a[136:139], v[140:143]
v_mfma_f32_16x16x32_bf16 v[144:147], a[204:207], a[136:139], v[144:147]
buffer_load_dwordx4 a[244:247], v13, s[44:47], s58 offen offset:2048 sc1
v_mfma_f32_16x16x32_bf16 v[148:151], a[208:211], a[136:139], v[148:151]
ds_read_b128 a[136:139], v21 offset:47232
s_waitcnt lgkmcnt(4)
v_mfma_f32_16x16x32_bf16 v[160:163], a[208:211], a[140:143], v[160:163]
v_mfma_f32_16x16x32_bf16 v[156:159], a[204:207], a[140:143], v[156:159]
v_mfma_f32_16x16x32_bf16 v[152:155], a[200:203], a[140:143], v[152:155]
ds_read_b128 a[140:143], v22 offset:47232
v_mfma_f32_16x16x32_bf16 v[164:167], a[200:203], a[144:147], v[164:167]
v_mfma_f32_16x16x32_bf16 v[168:171], a[204:207], a[144:147], v[168:171]
v_mfma_f32_16x16x32_bf16 v[172:175], a[208:211], a[144:147], v[172:175]
ds_read_b128 a[144:147], v23 offset:47232
v_mfma_f32_16x16x32_bf16 v[184:187], a[208:211], a[148:151], v[184:187]
v_mfma_f32_16x16x32_bf16 v[180:183], a[204:207], a[148:151], v[180:183]
v_mfma_f32_16x16x32_bf16 v[176:179], a[200:203], a[148:151], v[176:179]
ds_read_b128 a[148:151], v24 offset:47232
s_waitcnt lgkmcnt(4)
v_mfma_f32_16x16x32_bf16 v[188:191], a[200:203], a[152:155], v[188:191]
ds_write_b128 v26, a[78:81] offset:39744
v_mfma_f32_16x16x32_bf16 v[192:195], a[204:207], a[152:155], v[192:195]
s_waitcnt vmcnt(9)
v_mfma_f32_16x16x32_bf16 v[196:199], a[208:211], a[152:155], v[196:199]
ds_read_b128 a[152:155], v2 offset:47232
v_mfma_f32_16x16x32_bf16 v[116:119], a[212:215], a[128:131], v[116:119]
s_add_u32 s58, s3, 417792
v_mfma_f32_16x16x32_bf16 v[120:123], a[216:219], a[128:131], v[120:123]
buffer_load_dwordx4 a[200:203], v13, s[44:47], s58 offen sc1
v_mfma_f32_16x16x32_bf16 v[124:127], a[220:223], a[128:131], v[124:127]
ds_read_b128 a[128:131], v19 offset:47296
v_mfma_f32_16x16x32_bf16 v[136:139], a[220:223], a[132:135], v[136:139]
v_mfma_f32_16x16x32_bf16 v[132:135], a[216:219], a[132:135], v[132:135]
buffer_load_dwordx4 a[204:207], v13, s[44:47], s58 offen offset:1024 sc1
v_mfma_f32_16x16x32_bf16 v[128:131], a[212:215], a[132:135], v[128:131]
ds_read_b128 a[132:135], v20 offset:47296
s_waitcnt lgkmcnt(5)
v_mfma_f32_16x16x32_bf16 v[140:143], a[212:215], a[136:139], v[140:143]
v_mfma_f32_16x16x32_bf16 v[144:147], a[216:219], a[136:139], v[144:147]
buffer_load_dwordx4 a[208:211], v13, s[44:47], s58 offen offset:2048 sc1
v_mfma_f32_16x16x32_bf16 v[148:151], a[220:223], a[136:139], v[148:151]
ds_read_b128 a[136:139], v21 offset:47296
v_mfma_f32_16x16x32_bf16 v[160:163], a[220:223], a[140:143], v[160:163]
v_mfma_f32_16x16x32_bf16 v[156:159], a[216:219], a[140:143], v[156:159]
v_mfma_f32_16x16x32_bf16 v[152:155], a[212:215], a[140:143], v[152:155]
ds_read_b128 a[140:143], v22 offset:47296
v_mfma_f32_16x16x32_bf16 v[164:167], a[212:215], a[144:147], v[164:167]
v_mfma_f32_16x16x32_bf16 v[168:171], a[216:219], a[144:147], v[168:171]
v_mfma_f32_16x16x32_bf16 v[172:175], a[220:223], a[144:147], v[172:175]
ds_read_b128 a[144:147], v23 offset:47296
s_waitcnt lgkmcnt(4)
v_mfma_f32_16x16x32_bf16 v[184:187], a[220:223], a[148:151], v[184:187]
v_mfma_f32_16x16x32_bf16 v[180:183], a[216:219], a[148:151], v[180:183]
v_mfma_f32_16x16x32_bf16 v[176:179], a[212:215], a[148:151], v[176:179]
ds_read_b128 a[148:151], v24 offset:47296
v_mfma_f32_16x16x32_bf16 v[188:191], a[212:215], a[152:155], v[188:191]
ds_write_b64 v14, a[82:83] offset:39744
v_mfma_f32_16x16x32_bf16 v[192:195], a[216:219], a[152:155], v[192:195]
s_waitcnt vmcnt(9)
v_mfma_f32_16x16x32_bf16 v[196:199], a[220:223], a[152:155], v[196:199]
ds_read_b128 a[152:155], v2 offset:47296
v_mfma_f32_16x16x32_bf16 v[116:119], a[224:227], a[128:131], v[116:119]
s_add_u32 s58, s3, 430080
v_mfma_f32_16x16x32_bf16 v[120:123], a[228:231], a[128:131], v[120:123]
buffer_load_dwordx4 a[212:215], v13, s[44:47], s58 offen sc1
v_mfma_f32_16x16x32_bf16 v[124:127], a[232:235], a[128:131], v[124:127]
ds_read_b128 a[128:131], v19 offset:47360
s_waitcnt lgkmcnt(5)
v_mfma_f32_16x16x32_bf16 v[136:139], a[232:235], a[132:135], v[136:139]
v_mfma_f32_16x16x32_bf16 v[132:135], a[228:231], a[132:135], v[132:135]
buffer_load_dwordx4 a[216:219], v13, s[44:47], s58 offen offset:1024 sc1
v_mfma_f32_16x16x32_bf16 v[128:131], a[224:227], a[132:135], v[128:131]
ds_read_b128 a[132:135], v20 offset:47360
v_mfma_f32_16x16x32_bf16 v[140:143], a[224:227], a[136:139], v[140:143]
v_mfma_f32_16x16x32_bf16 v[144:147], a[228:231], a[136:139], v[144:147]
buffer_load_dwordx4 a[220:223], v13, s[44:47], s58 offen offset:2048 sc1
v_mfma_f32_16x16x32_bf16 v[148:151], a[232:235], a[136:139], v[148:151]
ds_read_b128 a[136:139], v21 offset:47360
v_mfma_f32_16x16x32_bf16 v[160:163], a[232:235], a[140:143], v[160:163]
s_add_u32 s59, s3, 737280
v_mfma_f32_16x16x32_bf16 v[156:159], a[228:231], a[140:143], v[156:159]
buffer_load_dwordx4 a[72:75], v13, s[44:47], s59 offen sc1
v_mfma_f32_16x16x32_bf16 v[152:155], a[224:227], a[140:143], v[152:155]
ds_read_b128 a[140:143], v22 offset:47360
s_waitcnt lgkmcnt(4)
v_mfma_f32_16x16x32_bf16 v[164:167], a[224:227], a[144:147], v[164:167]
v_mfma_f32_16x16x32_bf16 v[168:171], a[228:231], a[144:147], v[168:171]
buffer_load_dwordx4 a[76:79], v13, s[44:47], s59 offen offset:1024 sc1
v_mfma_f32_16x16x32_bf16 v[172:175], a[232:235], a[144:147], v[172:175]
ds_read_b128 a[144:147], v23 offset:47360
v_mfma_f32_16x16x32_bf16 v[184:187], a[232:235], a[148:151], v[184:187]
v_mfma_f32_16x16x32_bf16 v[180:183], a[228:231], a[148:151], v[180:183]
buffer_load_dwordx4 a[80:83], v13, s[44:47], s59 offen offset:2048 sc1
v_mfma_f32_16x16x32_bf16 v[176:179], a[224:227], a[148:151], v[176:179]
ds_read_b128 a[148:151], v24 offset:47360
v_mfma_f32_16x16x32_bf16 v[188:191], a[224:227], a[152:155], v[188:191]
v_mfma_f32_16x16x32_bf16 v[192:195], a[228:231], a[152:155], v[192:195]
s_waitcnt vmcnt(9)
v_mfma_f32_16x16x32_bf16 v[196:199], a[232:235], a[152:155], v[196:199]
ds_read_b128 a[152:155], v2 offset:47360
s_waitcnt lgkmcnt(4)
v_mfma_f32_16x16x32_bf16 v[116:119], a[236:239], a[128:131], v[116:119]
s_add_u32 s58, s3, 442368
v_mfma_f32_16x16x32_bf16 v[120:123], a[240:243], a[128:131], v[120:123]
buffer_load_dwordx4 a[224:227], v13, s[44:47], s58 offen sc1
v_mfma_f32_16x16x32_bf16 v[124:127], a[244:247], a[128:131], v[124:127]
ds_read_b128 a[128:131], v19 offset:47424
v_mfma_f32_16x16x32_bf16 v[136:139], a[244:247], a[132:135], v[136:139]
v_mfma_f32_16x16x32_bf16 v[132:135], a[240:243], a[132:135], v[132:135]
buffer_load_dwordx4 a[228:231], v13, s[44:47], s58 offen offset:1024 sc1
v_mfma_f32_16x16x32_bf16 v[128:131], a[236:239], a[132:135], v[128:131]
ds_read_b128 a[132:135], v20 offset:47424
v_mfma_f32_16x16x32_bf16 v[140:143], a[236:239], a[136:139], v[140:143]
v_mfma_f32_16x16x32_bf16 v[144:147], a[240:243], a[136:139], v[144:147]
buffer_load_dwordx4 a[232:235], v13, s[44:47], s58 offen offset:2048 sc1
v_mfma_f32_16x16x32_bf16 v[148:151], a[244:247], a[136:139], v[148:151]
ds_read_b128 a[136:139], v21 offset:47424
s_waitcnt lgkmcnt(4)
v_mfma_f32_16x16x32_bf16 v[160:163], a[244:247], a[140:143], v[160:163]
v_mfma_f32_16x16x32_bf16 v[156:159], a[240:243], a[140:143], v[156:159]
v_mfma_f32_16x16x32_bf16 v[152:155], a[236:239], a[140:143], v[152:155]
ds_read_b128 a[140:143], v22 offset:47424
v_mfma_f32_16x16x32_bf16 v[164:167], a[236:239], a[144:147], v[164:167]
v_mfma_f32_16x16x32_bf16 v[168:171], a[240:243], a[144:147], v[168:171]
v_mfma_f32_16x16x32_bf16 v[172:175], a[244:247], a[144:147], v[172:175]
ds_read_b128 a[144:147], v23 offset:47424
v_mfma_f32_16x16x32_bf16 v[184:187], a[244:247], a[148:151], v[184:187]
v_mfma_f32_16x16x32_bf16 v[180:183], a[240:243], a[148:151], v[180:183]
v_mfma_f32_16x16x32_bf16 v[176:179], a[236:239], a[148:151], v[176:179]
ds_read_b128 a[148:151], v24 offset:47424
s_waitcnt lgkmcnt(4)
v_mfma_f32_16x16x32_bf16 v[188:191], a[236:239], a[152:155], v[188:191]
v_mfma_f32_16x16x32_bf16 v[192:195], a[240:243], a[152:155], v[192:195]
s_waitcnt vmcnt(9)
v_mfma_f32_16x16x32_bf16 v[196:199], a[244:247], a[152:155], v[196:199]
ds_read_b128 a[152:155], v2 offset:47424
v_mfma_f32_16x16x32_bf16 v[116:119], a[200:203], a[128:131], v[116:119]
s_add_u32 s58, s3, 454656
v_mfma_f32_16x16x32_bf16 v[120:123], a[204:207], a[128:131], v[120:123]
buffer_load_dwordx4 a[236:239], v13, s[44:47], s58 offen sc1
v_mfma_f32_16x16x32_bf16 v[124:127], a[208:211], a[128:131], v[124:127]
ds_read_b128 a[128:131], v19 offset:47488
v_mfma_f32_16x16x32_bf16 v[136:139], a[208:211], a[132:135], v[136:139]
v_mfma_f32_16x16x32_bf16 v[132:135], a[204:207], a[132:135], v[132:135]
buffer_load_dwordx4 a[240:243], v13, s[44:47], s58 offen offset:1024 sc1
v_mfma_f32_16x16x32_bf16 v[128:131], a[200:203], a[132:135], v[128:131]
ds_read_b128 a[132:135], v20 offset:47488
s_waitcnt lgkmcnt(4)
v_mfma_f32_16x16x32_bf16 v[140:143], a[200:203], a[136:139], v[140:143]
v_mfma_f32_16x16x32_bf16 v[144:147], a[204:207], a[136:139], v[144:147]
buffer_load_dwordx4 a[244:247], v13, s[44:47], s58 offen offset:2048 sc1
v_mfma_f32_16x16x32_bf16 v[148:151], a[208:211], a[136:139], v[148:151]
ds_read_b128 a[136:139], v21 offset:47488
v_mfma_f32_16x16x32_bf16 v[160:163], a[208:211], a[140:143], v[160:163]
v_mfma_f32_16x16x32_bf16 v[156:159], a[204:207], a[140:143], v[156:159]
v_mfma_f32_16x16x32_bf16 v[152:155], a[200:203], a[140:143], v[152:155]
ds_read_b128 a[140:143], v22 offset:47488
v_mfma_f32_16x16x32_bf16 v[164:167], a[200:203], a[144:147], v[164:167]
v_mfma_f32_16x16x32_bf16 v[168:171], a[204:207], a[144:147], v[168:171]
v_mfma_f32_16x16x32_bf16 v[172:175], a[208:211], a[144:147], v[172:175]
ds_read_b128 a[144:147], v23 offset:47488
s_waitcnt lgkmcnt(4)
v_mfma_f32_16x16x32_bf16 v[184:187], a[208:211], a[148:151], v[184:187]
v_mfma_f32_16x16x32_bf16 v[180:183], a[204:207], a[148:151], v[180:183]
v_mfma_f32_16x16x32_bf16 v[176:179], a[200:203], a[148:151], v[176:179]
ds_read_b128 a[148:151], v24 offset:47488
v_mfma_f32_16x16x32_bf16 v[188:191], a[200:203], a[152:155], v[188:191]
v_mfma_f32_16x16x32_bf16 v[192:195], a[204:207], a[152:155], v[192:195]
s_waitcnt vmcnt(9)
v_mfma_f32_16x16x32_bf16 v[196:199], a[208:211], a[152:155], v[196:199]
ds_read_b128 a[152:155], v2 offset:47488
v_mfma_f32_16x16x32_bf16 v[116:119], a[212:215], a[128:131], v[116:119]
s_add_u32 s58, s3, 466944
v_mfma_f32_16x16x32_bf16 v[120:123], a[216:219], a[128:131], v[120:123]
buffer_load_dwordx4 a[200:203], v13, s[44:47], s58 offen sc1
v_mfma_f32_16x16x32_bf16 v[124:127], a[220:223], a[128:131], v[124:127]
s_waitcnt lgkmcnt(3)
v_mfma_f32_16x16x32_bf16 v[136:139], a[220:223], a[132:135], v[136:139]
v_mfma_f32_16x16x32_bf16 v[132:135], a[216:219], a[132:135], v[132:135]
buffer_load_dwordx4 a[204:207], v13, s[44:47], s58 offen offset:1024 sc1
v_mfma_f32_16x16x32_bf16 v[128:131], a[212:215], a[132:135], v[128:131]
s_waitcnt lgkmcnt(0)
s_barrier
v_mfma_f32_16x16x32_bf16 v[140:143], a[212:215], a[136:139], v[140:143]
ds_read_b128 a[128:131], v19 offset:0
v_mfma_f32_16x16x32_bf16 v[144:147], a[216:219], a[136:139], v[144:147]
buffer_load_dwordx4 a[208:211], v13, s[44:47], s58 offen offset:2048 sc1
ds_read_b128 a[132:135], v20 offset:0
v_mfma_f32_16x16x32_bf16 v[148:151], a[220:223], a[136:139], v[148:151]
ds_read_b128 a[136:139], v21 offset:0
v_mfma_f32_16x16x32_bf16 v[160:163], a[220:223], a[140:143], v[160:163]
v_mfma_f32_16x16x32_bf16 v[156:159], a[216:219], a[140:143], v[156:159]
v_mfma_f32_16x16x32_bf16 v[152:155], a[212:215], a[140:143], v[152:155]
ds_read_b128 a[140:143], v22 offset:0
v_mfma_f32_16x16x32_bf16 v[164:167], a[212:215], a[144:147], v[164:167]
v_mfma_f32_16x16x32_bf16 v[168:171], a[216:219], a[144:147], v[168:171]
v_mfma_f32_16x16x32_bf16 v[172:175], a[220:223], a[144:147], v[172:175]
ds_read_b128 a[144:147], v23 offset:0
v_mfma_f32_16x16x32_bf16 v[184:187], a[220:223], a[148:151], v[184:187]
v_mfma_f32_16x16x32_bf16 v[180:183], a[216:219], a[148:151], v[180:183]
v_mfma_f32_16x16x32_bf16 v[176:179], a[212:215], a[148:151], v[176:179]
ds_read_b128 a[148:151], v24 offset:0
v_mfma_f32_16x16x32_bf16 v[188:191], a[212:215], a[152:155], v[188:191]
v_mfma_f32_16x16x32_bf16 v[192:195], a[216:219], a[152:155], v[192:195]
s_waitcnt vmcnt(6)
v_mfma_f32_16x16x32_bf16 v[196:199], a[220:223], a[152:155], v[196:199]
ds_read_b128 a[152:155], v25 offset:0
s_waitcnt lgkmcnt(4)
v_mfma_f32_16x16x32_bf16 v[32:35], a[224:227], a[128:131], v[32:35]
s_add_u32 s58, s3, 479232
v_mfma_f32_16x16x32_bf16 v[36:39], a[228:231], a[128:131], v[36:39]
buffer_load_dwordx4 a[212:215], v13, s[44:47], s58 offen sc1
v_mfma_f32_16x16x32_bf16 v[40:43], a[232:235], a[128:131], v[40:43]
ds_read_b128 a[128:131], v19 offset:64
v_mfma_f32_16x16x32_bf16 v[52:55], a[232:235], a[132:135], v[52:55]
v_mfma_f32_16x16x32_bf16 v[48:51], a[228:231], a[132:135], v[48:51]
buffer_load_dwordx4 a[216:219], v13, s[44:47], s58 offen offset:1024 sc1
v_mfma_f32_16x16x32_bf16 v[44:47], a[224:227], a[132:135], v[44:47]
ds_read_b128 a[132:135], v20 offset:64
v_mfma_f32_16x16x32_bf16 v[56:59], a[224:227], a[136:139], v[56:59]
v_mfma_f32_16x16x32_bf16 v[60:63], a[228:231], a[136:139], v[60:63]
buffer_load_dwordx4 a[220:223], v13, s[44:47], s58 offen offset:2048 sc1
v_mfma_f32_16x16x32_bf16 v[64:67], a[232:235], a[136:139], v[64:67]
ds_read_b128 a[136:139], v21 offset:64
s_waitcnt lgkmcnt(4)
v_mfma_f32_16x16x32_bf16 v[76:79], a[232:235], a[140:143], v[76:79]
v_mfma_f32_16x16x32_bf16 v[72:75], a[228:231], a[140:143], v[72:75]
v_mfma_f32_16x16x32_bf16 v[68:71], a[224:227], a[140:143], v[68:71]
ds_read_b128 a[140:143], v22 offset:64
v_mfma_f32_16x16x32_bf16 v[80:83], a[224:227], a[144:147], v[80:83]
v_mfma_f32_16x16x32_bf16 v[84:87], a[228:231], a[144:147], v[84:87]
v_mfma_f32_16x16x32_bf16 v[88:91], a[232:235], a[144:147], v[88:91]
ds_read_b128 a[144:147], v23 offset:64
v_mfma_f32_16x16x32_bf16 v[100:103], a[232:235], a[148:151], v[100:103]
v_mfma_f32_16x16x32_bf16 v[96:99], a[228:231], a[148:151], v[96:99]
v_mfma_f32_16x16x32_bf16 v[92:95], a[224:227], a[148:151], v[92:95]
ds_read_b128 a[148:151], v24 offset:64
s_waitcnt lgkmcnt(4)
v_mfma_f32_16x16x32_bf16 v[104:107], a[224:227], a[152:155], v[104:107]
v_mfma_f32_16x16x32_bf16 v[108:111], a[228:231], a[152:155], v[108:111]
s_waitcnt vmcnt(6)
v_mfma_f32_16x16x32_bf16 v[112:115], a[232:235], a[152:155], v[112:115]
ds_read_b128 a[152:155], v25 offset:64
v_mfma_f32_16x16x32_bf16 v[32:35], a[236:239], a[128:131], v[32:35]
s_add_u32 s58, s3, 491520
v_mfma_f32_16x16x32_bf16 v[36:39], a[240:243], a[128:131], v[36:39]
buffer_load_dwordx4 a[224:227], v13, s[44:47], s58 offen sc1
v_mfma_f32_16x16x32_bf16 v[40:43], a[244:247], a[128:131], v[40:43]
ds_read_b128 a[128:131], v19 offset:128
v_mfma_f32_16x16x32_bf16 v[52:55], a[244:247], a[132:135], v[52:55]
v_mfma_f32_16x16x32_bf16 v[48:51], a[240:243], a[132:135], v[48:51]
buffer_load_dwordx4 a[228:231], v13, s[44:47], s58 offen offset:1024 sc1
v_mfma_f32_16x16x32_bf16 v[44:47], a[236:239], a[132:135], v[44:47]
ds_read_b128 a[132:135], v20 offset:128
s_waitcnt lgkmcnt(4)
v_mfma_f32_16x16x32_bf16 v[56:59], a[236:239], a[136:139], v[56:59]
v_mfma_f32_16x16x32_bf16 v[60:63], a[240:243], a[136:139], v[60:63]
buffer_load_dwordx4 a[232:235], v13, s[44:47], s58 offen offset:2048 sc1
v_mfma_f32_16x16x32_bf16 v[64:67], a[244:247], a[136:139], v[64:67]
ds_read_b128 a[136:139], v21 offset:128
v_mfma_f32_16x16x32_bf16 v[76:79], a[244:247], a[140:143], v[76:79]
v_mfma_f32_16x16x32_bf16 v[72:75], a[240:243], a[140:143], v[72:75]
v_mfma_f32_16x16x32_bf16 v[68:71], a[236:239], a[140:143], v[68:71]
ds_read_b128 a[140:143], v22 offset:128
v_mfma_f32_16x16x32_bf16 v[80:83], a[236:239], a[144:147], v[80:83]
v_mfma_f32_16x16x32_bf16 v[84:87], a[240:243], a[144:147], v[84:87]
v_mfma_f32_16x16x32_bf16 v[88:91], a[244:247], a[144:147], v[88:91]
ds_read_b128 a[144:147], v23 offset:128
s_waitcnt lgkmcnt(4)
v_mfma_f32_16x16x32_bf16 v[100:103], a[244:247], a[148:151], v[100:103]
v_mfma_f32_16x16x32_bf16 v[96:99], a[240:243], a[148:151], v[96:99]
v_mfma_f32_16x16x32_bf16 v[92:95], a[236:239], a[148:151], v[92:95]
ds_read_b128 a[148:151], v24 offset:128
v_mfma_f32_16x16x32_bf16 v[104:107], a[236:239], a[152:155], v[104:107]
v_mfma_f32_16x16x32_bf16 v[108:111], a[240:243], a[152:155], v[108:111]
s_waitcnt vmcnt(6)
v_mfma_f32_16x16x32_bf16 v[112:115], a[244:247], a[152:155], v[112:115]
ds_read_b128 a[152:155], v25 offset:128
v_mfma_f32_16x16x32_bf16 v[32:35], a[200:203], a[128:131], v[32:35]
s_add_u32 s58, s3, 503808
v_mfma_f32_16x16x32_bf16 v[36:39], a[204:207], a[128:131], v[36:39]
buffer_load_dwordx4 a[236:239], v13, s[44:47], s58 offen sc1
v_mfma_f32_16x16x32_bf16 v[40:43], a[208:211], a[128:131], v[40:43]
ds_read_b128 a[128:131], v19 offset:192
s_waitcnt lgkmcnt(4)
v_mfma_f32_16x16x32_bf16 v[52:55], a[208:211], a[132:135], v[52:55]
v_mfma_f32_16x16x32_bf16 v[48:51], a[204:207], a[132:135], v[48:51]
buffer_load_dwordx4 a[240:243], v13, s[44:47], s58 offen offset:1024 sc1
v_mfma_f32_16x16x32_bf16 v[44:47], a[200:203], a[132:135], v[44:47]
ds_read_b128 a[132:135], v20 offset:192
v_mfma_f32_16x16x32_bf16 v[56:59], a[200:203], a[136:139], v[56:59]
v_fma_f32 v32, v116, -0.5, v32
v_fma_f32 v33, v117, -0.5, v33
v_mfma_f32_16x16x32_bf16 v[60:63], a[204:207], a[136:139], v[60:63]
buffer_load_dwordx4 a[244:247], v13, s[44:47], s58 offen offset:2048 sc1
v_mfma_f32_16x16x32_bf16 v[64:67], a[208:211], a[136:139], v[64:67]
ds_read_b128 a[136:139], v21 offset:192
v_mfma_f32_16x16x32_bf16 v[76:79], a[208:211], a[140:143], v[76:79]
v_fma_f32 v34, v118, -0.5, v34
v_fma_f32 v35, v119, -0.5, v35
v_mfma_f32_16x16x32_bf16 v[72:75], a[204:207], a[140:143], v[72:75]
v_fma_f32 v36, v120, -0.5, v36
v_fma_f32 v37, v121, -0.5, v37
v_mfma_f32_16x16x32_bf16 v[68:71], a[200:203], a[140:143], v[68:71]
ds_read_b128 a[140:143], v22 offset:192
s_waitcnt lgkmcnt(4)
v_mfma_f32_16x16x32_bf16 v[80:83], a[200:203], a[144:147], v[80:83]
v_fma_f32 v38, v122, -0.5, v38
v_fma_f32 v39, v123, -0.5, v39
v_mfma_f32_16x16x32_bf16 v[84:87], a[204:207], a[144:147], v[84:87]
v_mfma_f32_16x16x32_bf16 v[88:91], a[208:211], a[144:147], v[88:91]
ds_read_b128 a[144:147], v23 offset:192
v_mfma_f32_16x16x32_bf16 v[100:103], a[208:211], a[148:151], v[100:103]
v_mfma_f32_16x16x32_bf16 v[96:99], a[204:207], a[148:151], v[96:99]
v_mfma_f32_16x16x32_bf16 v[92:95], a[200:203], a[148:151], v[92:95]
ds_read_b128 a[148:151], v24 offset:192
v_mfma_f32_16x16x32_bf16 v[104:107], a[200:203], a[152:155], v[104:107]
v_mfma_f32_16x16x32_bf16 v[108:111], a[204:207], a[152:155], v[108:111]
s_waitcnt vmcnt(6)
v_mfma_f32_16x16x32_bf16 v[112:115], a[208:211], a[152:155], v[112:115]
ds_read_b128 a[152:155], v25 offset:192
s_waitcnt lgkmcnt(4)
v_mfma_f32_16x16x32_bf16 v[32:35], a[212:215], a[128:131], v[32:35]
s_add_u32 s58, s3, 516096
v_mfma_f32_16x16x32_bf16 v[36:39], a[216:219], a[128:131], v[36:39]
buffer_load_dwordx4 a[200:203], v13, s[44:47], s58 offen sc1
v_mfma_f32_16x16x32_bf16 v[40:43], a[220:223], a[128:131], v[40:43]
ds_read_b128 a[128:131], v19 offset:256
v_mfma_f32_16x16x32_bf16 v[52:55], a[220:223], a[132:135], v[52:55]
v_mfma_f32_16x16x32_bf16 v[48:51], a[216:219], a[132:135], v[48:51]
buffer_load_dwordx4 a[204:207], v13, s[44:47], s58 offen offset:1024 sc1
v_mfma_f32_16x16x32_bf16 v[44:47], a[212:215], a[132:135], v[44:47]
ds_read_b128 a[132:135], v20 offset:256
v_mfma_f32_16x16x32_bf16 v[56:59], a[212:215], a[136:139], v[56:59]
v_mfma_f32_16x16x32_bf16 v[60:63], a[216:219], a[136:139], v[60:63]
buffer_load_dwordx4 a[208:211], v13, s[44:47], s58 offen offset:2048 sc1
v_mfma_f32_16x16x32_bf16 v[64:67], a[220:223], a[136:139], v[64:67]
ds_read_b128 a[136:139], v21 offset:256
s_waitcnt lgkmcnt(4)
v_mfma_f32_16x16x32_bf16 v[76:79], a[220:223], a[140:143], v[76:79]
v_fma_f32 v40, v124, -0.5, v40
v_fma_f32 v41, v125, -0.5, v41
v_mfma_f32_16x16x32_bf16 v[72:75], a[216:219], a[140:143], v[72:75]
v_fma_f32 v42, v126, -0.5, v42
v_fma_f32 v43, v127, -0.5, v43
v_mfma_f32_16x16x32_bf16 v[68:71], a[212:215], a[140:143], v[68:71]
ds_read_b128 a[140:143], v22 offset:256
v_mfma_f32_16x16x32_bf16 v[80:83], a[212:215], a[144:147], v[80:83]
v_fma_f32 v44, v128, -0.5, v44
v_fma_f32 v45, v129, -0.5, v45
v_mfma_f32_16x16x32_bf16 v[84:87], a[216:219], a[144:147], v[84:87]
v_fma_f32 v46, v130, -0.5, v46
v_fma_f32 v47, v131, -0.5, v47
v_mfma_f32_16x16x32_bf16 v[88:91], a[220:223], a[144:147], v[88:91]
ds_read_b128 a[144:147], v23 offset:256
v_mfma_f32_16x16x32_bf16 v[100:103], a[220:223], a[148:151], v[100:103]
v_mfma_f32_16x16x32_bf16 v[96:99], a[216:219], a[148:151], v[96:99]
v_mfma_f32_16x16x32_bf16 v[92:95], a[212:215], a[148:151], v[92:95]
ds_read_b128 a[148:151], v24 offset:256
s_waitcnt lgkmcnt(4)
v_mfma_f32_16x16x32_bf16 v[104:107], a[212:215], a[152:155], v[104:107]
ds_write_b128 v27, a[84:87] offset:0
v_mfma_f32_16x16x32_bf16 v[108:111], a[216:219], a[152:155], v[108:111]
s_waitcnt vmcnt(6)
v_mfma_f32_16x16x32_bf16 v[112:115], a[220:223], a[152:155], v[112:115]
ds_read_b128 a[152:155], v25 offset:256
v_mfma_f32_16x16x32_bf16 v[32:35], a[224:227], a[128:131], v[32:35]
s_add_u32 s58, s3, 528384
v_mfma_f32_16x16x32_bf16 v[36:39], a[228:231], a[128:131], v[36:39]
buffer_load_dwordx4 a[212:215], v13, s[44:47], s58 offen sc1
v_mfma_f32_16x16x32_bf16 v[40:43], a[232:235], a[128:131], v[40:43]
ds_read_b128 a[128:131], v19 offset:320
v_mfma_f32_16x16x32_bf16 v[52:55], a[232:235], a[132:135], v[52:55]
v_mfma_f32_16x16x32_bf16 v[48:51], a[228:231], a[132:135], v[48:51]
buffer_load_dwordx4 a[216:219], v13, s[44:47], s58 offen offset:1024 sc1
v_mfma_f32_16x16x32_bf16 v[44:47], a[224:227], a[132:135], v[44:47]
ds_read_b128 a[132:135], v20 offset:320
s_waitcnt lgkmcnt(5)
v_mfma_f32_16x16x32_bf16 v[56:59], a[224:227], a[136:139], v[56:59]
v_mfma_f32_16x16x32_bf16 v[60:63], a[228:231], a[136:139], v[60:63]
buffer_load_dwordx4 a[220:223], v13, s[44:47], s58 offen offset:2048 sc1
v_mfma_f32_16x16x32_bf16 v[64:67], a[232:235], a[136:139], v[64:67]
ds_read_b128 a[136:139], v21 offset:320
v_mfma_f32_16x16x32_bf16 v[76:79], a[232:235], a[140:143], v[76:79]
v_mfma_f32_16x16x32_bf16 v[72:75], a[228:231], a[140:143], v[72:75]
v_fma_f32 v48, v132, -0.5, v48
v_fma_f32 v49, v133, -0.5, v49
v_mfma_f32_16x16x32_bf16 v[68:71], a[224:227], a[140:143], v[68:71]
ds_read_b128 a[140:143], v22 offset:320
v_mfma_f32_16x16x32_bf16 v[80:83], a[224:227], a[144:147], v[80:83]
v_fma_f32 v50, v134, -0.5, v50
v_fma_f32 v51, v135, -0.5, v51
v_mfma_f32_16x16x32_bf16 v[84:87], a[228:231], a[144:147], v[84:87]
v_fma_f32 v52, v136, -0.5, v52
v_fma_f32 v53, v137, -0.5, v53
v_mfma_f32_16x16x32_bf16 v[88:91], a[232:235], a[144:147], v[88:91]
ds_read_b128 a[144:147], v23 offset:320
s_waitcnt lgkmcnt(4)
v_mfma_f32_16x16x32_bf16 v[100:103], a[232:235], a[148:151], v[100:103]
v_fma_f32 v54, v138, -0.5, v54
v_fma_f32 v55, v139, -0.5, v55
v_mfma_f32_16x16x32_bf16 v[96:99], a[228:231], a[148:151], v[96:99]
ds_write_b128 v27, a[90:93] offset:6624
v_mfma_f32_16x16x32_bf16 v[92:95], a[224:227], a[148:151], v[92:95]
ds_read_b128 a[148:151], v24 offset:320
v_mfma_f32_16x16x32_bf16 v[104:107], a[224:227], a[152:155], v[104:107]
ds_write_b64 v15, a[88:89] offset:0
v_mfma_f32_16x16x32_bf16 v[108:111], a[228:231], a[152:155], v[108:111]
s_waitcnt vmcnt(6)
v_mfma_f32_16x16x32_bf16 v[112:115], a[232:235], a[152:155], v[112:115]
ds_read_b128 a[152:155], v25 offset:320
v_mfma_f32_16x16x32_bf16 v[32:35], a[236:239], a[128:131], v[32:35]
s_add_u32 s58, s3, 540672
v_mfma_f32_16x16x32_bf16 v[36:39], a[240:243], a[128:131], v[36:39]
buffer_load_dwordx4 a[224:227], v13, s[44:47], s58 offen sc1
v_mfma_f32_16x16x32_bf16 v[40:43], a[244:247], a[128:131], v[40:43]
ds_read_b128 a[128:131], v19 offset:400
s_waitcnt lgkmcnt(6)
v_mfma_f32_16x16x32_bf16 v[52:55], a[244:247], a[132:135], v[52:55]
v_mfma_f32_16x16x32_bf16 v[48:51], a[240:243], a[132:135], v[48:51]
buffer_load_dwordx4 a[228:231], v13, s[44:47], s58 offen offset:1024 sc1
v_mfma_f32_16x16x32_bf16 v[44:47], a[236:239], a[132:135], v[44:47]
ds_read_b128 a[132:135], v20 offset:400
v_mfma_f32_16x16x32_bf16 v[56:59], a[236:239], a[136:139], v[56:59]
v_mfma_f32_16x16x32_bf16 v[60:63], a[240:243], a[136:139], v[60:63]
buffer_load_dwordx4 a[232:235], v13, s[44:47], s58 offen offset:2048 sc1
v_mfma_f32_16x16x32_bf16 v[64:67], a[244:247], a[136:139], v[64:67]
ds_read_b128 a[136:139], v21 offset:400
v_mfma_f32_16x16x32_bf16 v[76:79], a[244:247], a[140:143], v[76:79]
v_mfma_f32_16x16x32_bf16 v[72:75], a[240:243], a[140:143], v[72:75]
v_mfma_f32_16x16x32_bf16 v[68:71], a[236:239], a[140:143], v[68:71]
ds_read_b128 a[140:143], v22 offset:400
s_waitcnt lgkmcnt(4)
v_mfma_f32_16x16x32_bf16 v[80:83], a[236:239], a[144:147], v[80:83]
v_fma_f32 v56, v140, -0.5, v56
v_fma_f32 v57, v141, -0.5, v57
v_mfma_f32_16x16x32_bf16 v[84:87], a[240:243], a[144:147], v[84:87]
v_fma_f32 v58, v142, -0.5, v58
v_fma_f32 v59, v143, -0.5, v59
v_mfma_f32_16x16x32_bf16 v[88:91], a[244:247], a[144:147], v[88:91]
ds_read_b128 a[144:147], v23 offset:400
v_mfma_f32_16x16x32_bf16 v[100:103], a[244:247], a[148:151], v[100:103]
v_fma_f32 v60, v144, -0.5, v60
v_fma_f32 v61, v145, -0.5, v61
v_mfma_f32_16x16x32_bf16 v[96:99], a[240:243], a[148:151], v[96:99]
v_fma_f32 v62, v146, -0.5, v62
v_fma_f32 v63, v147, -0.5, v63
v_mfma_f32_16x16x32_bf16 v[92:95], a[236:239], a[148:151], v[92:95]
ds_read_b128 a[148:151], v24 offset:400
v_mfma_f32_16x16x32_bf16 v[104:107], a[236:239], a[152:155], v[104:107]
ds_write_b64 v15, a[94:95] offset:6624
v_mfma_f32_16x16x32_bf16 v[108:111], a[240:243], a[152:155], v[108:111]
s_waitcnt vmcnt(6)
v_mfma_f32_16x16x32_bf16 v[112:115], a[244:247], a[152:155], v[112:115]
ds_read_b128 a[152:155], v25 offset:400
s_waitcnt lgkmcnt(5)
v_mfma_f32_16x16x32_bf16 v[32:35], a[200:203], a[128:131], v[32:35]
s_add_u32 s58, s3, 552960
v_fma_f32 v68, v152, -0.5, v68
v_mfma_f32_16x16x32_bf16 v[36:39], a[204:207], a[128:131], v[36:39]
buffer_load_dwordx4 a[236:239], v13, s[44:47], s58 offen sc1
v_mfma_f32_16x16x32_bf16 v[40:43], a[208:211], a[128:131], v[40:43]
ds_read_b128 a[128:131], v19 offset:464
v_mfma_f32_16x16x32_bf16 v[52:55], a[208:211], a[132:135], v[52:55]
v_fma_f32 v69, v153, -0.5, v69
v_fma_f32 v70, v154, -0.5, v70
v_mfma_f32_16x16x32_bf16 v[48:51], a[204:207], a[132:135], v[48:51]
buffer_load_dwordx4 a[240:243], v13, s[44:47], s58 offen offset:1024 sc1
v_mfma_f32_16x16x32_bf16 v[44:47], a[200:203], a[132:135], v[44:47]
ds_read_b128 a[132:135], v20 offset:464
v_mfma_f32_16x16x32_bf16 v[56:59], a[200:203], a[136:139], v[56:59]
v_fma_f32 v71, v155, -0.5, v71
v_mfma_f32_16x16x32_bf16 v[60:63], a[204:207], a[136:139], v[60:63]
buffer_load_dwordx4 a[244:247], v13, s[44:47], s58 offen offset:2048 sc1
v_mfma_f32_16x16x32_bf16 v[64:67], a[208:211], a[136:139], v[64:67]
ds_read_b128 a[136:139], v21 offset:464
s_waitcnt lgkmcnt(4)
v_mfma_f32_16x16x32_bf16 v[76:79], a[208:211], a[140:143], v[76:79]
s_add_u32 s59, s3, 749568
v_mfma_f32_16x16x32_bf16 v[72:75], a[204:207], a[140:143], v[72:75]
buffer_load_dwordx4 a[84:87], v13, s[44:47], s59 offen sc1
v_mfma_f32_16x16x32_bf16 v[68:71], a[200:203], a[140:143], v[68:71]
ds_read_b128 a[140:143], v22 offset:464
v_mfma_f32_16x16x32_bf16 v[80:83], a[200:203], a[144:147], v[80:83]
ds_write_b128 v27, a[96:99] offset:13248
v_mfma_f32_16x16x32_bf16 v[84:87], a[204:207], a[144:147], v[84:87]
buffer_load_dwordx4 a[88:91], v13, s[44:47], s59 offen offset:1024 sc1
v_mfma_f32_16x16x32_bf16 v[88:91], a[208:211], a[144:147], v[88:91]
ds_read_b128 a[144:147], v23 offset:464
v_mfma_f32_16x16x32_bf16 v[100:103], a[208:211], a[148:151], v[100:103]
v_fma_f32 v64, v148, -0.5, v64
v_fma_f32 v65, v149, -0.5, v65
v_mfma_f32_16x16x32_bf16 v[96:99], a[204:207], a[148:151], v[96:99]
buffer_load_dwordx4 a[92:95], v13, s[44:47], s59 offen offset:2048 sc1
v_mfma_f32_16x16x32_bf16 v[92:95], a[200:203], a[148:151], v[92:95]
ds_read_b128 a[148:151], v24 offset:464
s_waitcnt lgkmcnt(5)
v_mfma_f32_16x16x32_bf16 v[104:107], a[200:203], a[152:155], v[104:107]
v_fma_f32 v66, v150, -0.5, v66
v_fma_f32 v67, v151, -0.5, v67
v_mfma_f32_16x16x32_bf16 v[108:111], a[204:207], a[152:155], v[108:111]
s_waitcnt vmcnt(9)
v_mfma_f32_16x16x32_bf16 v[112:115], a[208:211], a[152:155], v[112:115]
ds_read_b128 a[152:155], v25 offset:464
v_mfma_f32_16x16x32_bf16 v[32:35], a[212:215], a[128:131], v[32:35]
s_add_u32 s58, s3, 565248
v_fma_f32 v72, v156, -0.5, v72
v_mfma_f32_16x16x32_bf16 v[36:39], a[216:219], a[128:131], v[36:39]
buffer_load_dwordx4 a[200:203], v13, s[44:47], s58 offen sc1
v_mfma_f32_16x16x32_bf16 v[40:43], a[220:223], a[128:131], v[40:43]
ds_read_b128 a[128:131], v19 offset:528
v_mfma_f32_16x16x32_bf16 v[52:55], a[220:223], a[132:135], v[52:55]
v_fma_f32 v73, v157, -0.5, v73
v_fma_f32 v74, v158, -0.5, v74
v_mfma_f32_16x16x32_bf16 v[48:51], a[216:219], a[132:135], v[48:51]
buffer_load_dwordx4 a[204:207], v13, s[44:47], s58 offen offset:1024 sc1
v_mfma_f32_16x16x32_bf16 v[44:47], a[212:215], a[132:135], v[44:47]
ds_read_b128 a[132:135], v20 offset:528
s_waitcnt lgkmcnt(4)
v_mfma_f32_16x16x32_bf16 v[56:59], a[212:215], a[136:139], v[56:59]
v_fma_f32 v75, v159, -0.5, v75
v_fma_f32 v76, v160, -0.5, v76
v_fma_f32 v77, v161, -0.5, v77
v_mfma_f32_16x16x32_bf16 v[60:63], a[216:219], a[136:139], v[60:63]
buffer_load_dwordx4 a[208:211], v13, s[44:47], s58 offen offset:2048 sc1
v_fma_f32 v78, v162, -0.5, v78
v_mfma_f32_16x16x32_bf16 v[64:67], a[220:223], a[136:139], v[64:67]
ds_read_b128 a[136:139], v21 offset:528
v_fma_f32 v79, v163, -0.5, v79
s_nop 1
v_mfma_f32_16x16x32_bf16 v[76:79], a[220:223], a[140:143], v[76:79]
v_mfma_f32_16x16x32_bf16 v[72:75], a[216:219], a[140:143], v[72:75]
v_mfma_f32_16x16x32_bf16 v[68:71], a[212:215], a[140:143], v[68:71]
ds_read_b128 a[140:143], v22 offset:528
v_mfma_f32_16x16x32_bf16 v[80:83], a[212:215], a[144:147], v[80:83]
v_mfma_f32_16x16x32_bf16 v[84:87], a[216:219], a[144:147], v[84:87]
v_mfma_f32_16x16x32_bf16 v[88:91], a[220:223], a[144:147], v[88:91]
ds_read_b128 a[144:147], v23 offset:528
s_waitcnt lgkmcnt(4)
v_mfma_f32_16x16x32_bf16 v[100:103], a[220:223], a[148:151], v[100:103]
v_mfma_f32_16x16x32_bf16 v[96:99], a[216:219], a[148:151], v[96:99]
ds_write_b128 v27, a[102:105] offset:19872
v_mfma_f32_16x16x32_bf16 v[92:95], a[212:215], a[148:151], v[92:95]
ds_read_b128 a[148:151], v24 offset:528
v_mfma_f32_16x16x32_bf16 v[104:107], a[212:215], a[152:155], v[104:107]
ds_write_b64 v15, a[100:101] offset:13248
v_mfma_f32_16x16x32_bf16 v[108:111], a[216:219], a[152:155], v[108:111]
s_waitcnt vmcnt(9)
v_mfma_f32_16x16x32_bf16 v[112:115], a[220:223], a[152:155], v[112:115]
ds_read_b128 a[152:155], v25 offset:528
v_mfma_f32_16x16x32_bf16 v[32:35], a[224:227], a[128:131], v[32:35]
s_add_u32 s58, s3, 577536
v_fma_f32 v80, v164, -0.5, v80
v_mfma_f32_16x16x32_bf16 v[36:39], a[228:231], a[128:131], v[36:39]
buffer_load_dwordx4 a[212:215], v13, s[44:47], s58 offen sc1
v_mfma_f32_16x16x32_bf16 v[40:43], a[232:235], a[128:131], v[40:43]
ds_read_b128 a[128:131], v19 offset:592
s_waitcnt lgkmcnt(6)
v_mfma_f32_16x16x32_bf16 v[52:55], a[232:235], a[132:135], v[52:55]
v_fma_f32 v81, v165, -0.5, v81
v_fma_f32 v82, v166, -0.5, v82
v_mfma_f32_16x16x32_bf16 v[48:51], a[228:231], a[132:135], v[48:51]
buffer_load_dwordx4 a[216:219], v13, s[44:47], s58 offen offset:1024 sc1
v_mfma_f32_16x16x32_bf16 v[44:47], a[224:227], a[132:135], v[44:47]
ds_read_b128 a[132:135], v20 offset:592
v_mfma_f32_16x16x32_bf16 v[56:59], a[224:227], a[136:139], v[56:59]
v_fma_f32 v83, v167, -0.5, v83
v_fma_f32 v84, v168, -0.5, v84
v_mfma_f32_16x16x32_bf16 v[60:63], a[228:231], a[136:139], v[60:63]
buffer_load_dwordx4 a[220:223], v13, s[44:47], s58 offen offset:2048 sc1
v_mfma_f32_16x16x32_bf16 v[64:67], a[232:235], a[136:139], v[64:67]
ds_read_b128 a[136:139], v21 offset:592
v_mfma_f32_16x16x32_bf16 v[76:79], a[232:235], a[140:143], v[76:79]
v_fma_f32 v85, v169, -0.5, v85
v_fma_f32 v86, v170, -0.5, v86
v_mfma_f32_16x16x32_bf16 v[72:75], a[228:231], a[140:143], v[72:75]
v_fma_f32 v87, v171, -0.5, v87
v_mfma_f32_16x16x32_bf16 v[68:71], a[224:227], a[140:143], v[68:71]
ds_read_b128 a[140:143], v22 offset:592
s_waitcnt lgkmcnt(4)
v_mfma_f32_16x16x32_bf16 v[80:83], a[224:227], a[144:147], v[80:83]
v_mfma_f32_16x16x32_bf16 v[84:87], a[228:231], a[144:147], v[84:87]
v_mfma_f32_16x16x32_bf16 v[88:91], a[232:235], a[144:147], v[88:91]
ds_read_b128 a[144:147], v23 offset:592
v_mfma_f32_16x16x32_bf16 v[100:103], a[232:235], a[148:151], v[100:103]
v_mfma_f32_16x16x32_bf16 v[96:99], a[228:231], a[148:151], v[96:99]
v_mfma_f32_16x16x32_bf16 v[92:95], a[224:227], a[148:151], v[92:95]
ds_read_b128 a[148:151], v24 offset:592
v_mfma_f32_16x16x32_bf16 v[104:107], a[224:227], a[152:155], v[104:107]
ds_write_b64 v15, a[106:107] offset:19872
v_mfma_f32_16x16x32_bf16 v[108:111], a[228:231], a[152:155], v[108:111]
s_waitcnt vmcnt(9)
v_mfma_f32_16x16x32_bf16 v[112:115], a[232:235], a[152:155], v[112:115]
ds_read_b128 a[152:155], v25 offset:592
s_waitcnt lgkmcnt(5)
v_mfma_f32_16x16x32_bf16 v[32:35], a[236:239], a[128:131], v[32:35]
s_add_u32 s58, s3, 589824
v_fma_f32 v88, v172, -0.5, v88
v_mfma_f32_16x16x32_bf16 v[36:39], a[240:243], a[128:131], v[36:39]
buffer_load_dwordx4 a[224:227], v13, s[44:47], s58 offen sc1
v_mfma_f32_16x16x32_bf16 v[40:43], a[244:247], a[128:131], v[40:43]
ds_read_b128 a[128:131], v19 offset:656
v_mfma_f32_16x16x32_bf16 v[52:55], a[244:247], a[132:135], v[52:55]
v_fma_f32 v89, v173, -0.5, v89
v_fma_f32 v90, v174, -0.5, v90
v_mfma_f32_16x16x32_bf16 v[48:51], a[240:243], a[132:135], v[48:51]
buffer_load_dwordx4 a[228:231], v13, s[44:47], s58 offen offset:1024 sc1
v_mfma_f32_16x16x32_bf16 v[44:47], a[236:239], a[132:135], v[44:47]
ds_read_b128 a[132:135], v20 offset:656
v_mfma_f32_16x16x32_bf16 v[56:59], a[236:239], a[136:139], v[56:59]
v_fma_f32 v91, v175, -0.5, v91
v_fma_f32 v92, v176, -0.5, v92
v_mfma_f32_16x16x32_bf16 v[60:63], a[240:243], a[136:139], v[60:63]
buffer_load_dwordx4 a[232:235], v13, s[44:47], s58 offen offset:2048 sc1
v_mfma_f32_16x16x32_bf16 v[64:67], a[244:247], a[136:139], v[64:67]
ds_read_b128 a[136:139], v21 offset:656
s_waitcnt lgkmcnt(4)
v_mfma_f32_16x16x32_bf16 v[76:79], a[244:247], a[140:143], v[76:79]
s_add_u32 s59, s3, 761856
v_fma_f32 v93, v177, -0.5, v93
v_mfma_f32_16x16x32_bf16 v[72:75], a[240:243], a[140:143], v[72:75]
buffer_load_dwordx4 a[96:99], v13, s[44:47], s59 offen sc1
v_mfma_f32_16x16x32_bf16 v[68:71], a[236:239], a[140:143], v[68:71]
ds_read_b128 a[140:143], v22 offset:656
v_fma_f32 v94, v178, -0.5, v94
v_mfma_f32_16x16x32_bf16 v[80:83], a[236:239], a[144:147], v[80:83]
v_fma_f32 v95, v179, -0.5, v95
v_mfma_f32_16x16x32_bf16 v[84:87], a[240:243], a[144:147], v[84:87]
buffer_load_dwordx4 a[100:103], v13, s[44:47], s59 offen offset:1024 sc1
v_mfma_f32_16x16x32_bf16 v[88:91], a[244:247], a[144:147], v[88:91]
ds_read_b128 a[144:147], v23 offset:656
v_mfma_f32_16x16x32_bf16 v[100:103], a[244:247], a[148:151], v[100:103]
v_mfma_f32_16x16x32_bf16 v[96:99], a[240:243], a[148:151], v[96:99]
buffer_load_dwordx4 a[104:107], v13, s[44:47], s59 offen offset:2048 sc1
v_mfma_f32_16x16x32_bf16 v[92:95], a[236:239], a[148:151], v[92:95]
ds_read_b128 a[148:151], v24 offset:656
s_waitcnt lgkmcnt(4)
v_mfma_f32_16x16x32_bf16 v[104:107], a[236:239], a[152:155], v[104:107]
ds_write_b128 v27, a[108:111] offset:26496
v_mfma_f32_16x16x32_bf16 v[108:111], a[240:243], a[152:155], v[108:111]
s_waitcnt vmcnt(9)
v_mfma_f32_16x16x32_bf16 v[112:115], a[244:247], a[152:155], v[112:115]
ds_read_b128 a[152:155], v25 offset:656
v_mfma_f32_16x16x32_bf16 v[32:35], a[200:203], a[128:131], v[32:35]
s_add_u32 s58, s3, 602112
v_fma_f32 v96, v180, -0.5, v96
v_mfma_f32_16x16x32_bf16 v[36:39], a[204:207], a[128:131], v[36:39]
buffer_load_dwordx4 a[236:239], v13, s[44:47], s58 offen sc1
v_mfma_f32_16x16x32_bf16 v[40:43], a[208:211], a[128:131], v[40:43]
ds_read_b128 a[128:131], v19 offset:720
v_mfma_f32_16x16x32_bf16 v[52:55], a[208:211], a[132:135], v[52:55]
v_fma_f32 v97, v181, -0.5, v97
v_fma_f32 v98, v182, -0.5, v98
v_mfma_f32_16x16x32_bf16 v[48:51], a[204:207], a[132:135], v[48:51]
buffer_load_dwordx4 a[240:243], v13, s[44:47], s58 offen offset:1024 sc1
v_mfma_f32_16x16x32_bf16 v[44:47], a[200:203], a[132:135], v[44:47]
ds_read_b128 a[132:135], v20 offset:720
s_waitcnt lgkmcnt(5)
v_mfma_f32_16x16x32_bf16 v[56:59], a[200:203], a[136:139], v[56:59]
v_fma_f32 v99, v183, -0.5, v99
v_fma_f32 v100, v184, -0.5, v100
v_mfma_f32_16x16x32_bf16 v[60:63], a[204:207], a[136:139], v[60:63]
buffer_load_dwordx4 a[244:247], v13, s[44:47], s58 offen offset:2048 sc1
v_mfma_f32_16x16x32_bf16 v[64:67], a[208:211], a[136:139], v[64:67]
ds_read_b128 a[136:139], v21 offset:720
v_mfma_f32_16x16x32_bf16 v[76:79], a[208:211], a[140:143], v[76:79]
v_fma_f32 v101, v185, -0.5, v101
v_fma_f32 v102, v186, -0.5, v102
v_mfma_f32_16x16x32_bf16 v[72:75], a[204:207], a[140:143], v[72:75]
v_fma_f32 v103, v187, -0.5, v103
v_mfma_f32_16x16x32_bf16 v[68:71], a[200:203], a[140:143], v[68:71]
ds_read_b128 a[140:143], v22 offset:720
v_mfma_f32_16x16x32_bf16 v[80:83], a[200:203], a[144:147], v[80:83]
v_mfma_f32_16x16x32_bf16 v[84:87], a[204:207], a[144:147], v[84:87]
v_mfma_f32_16x16x32_bf16 v[88:91], a[208:211], a[144:147], v[88:91]
ds_read_b128 a[144:147], v23 offset:720
s_waitcnt lgkmcnt(4)
v_mfma_f32_16x16x32_bf16 v[100:103], a[208:211], a[148:151], v[100:103]
v_mfma_f32_16x16x32_bf16 v[96:99], a[204:207], a[148:151], v[96:99]
ds_write_b128 v27, a[114:117] offset:33120
v_mfma_f32_16x16x32_bf16 v[92:95], a[200:203], a[148:151], v[92:95]
ds_read_b128 a[148:151], v24 offset:720
v_mfma_f32_16x16x32_bf16 v[104:107], a[200:203], a[152:155], v[104:107]
ds_write_b64 v15, a[112:113] offset:26496
v_mfma_f32_16x16x32_bf16 v[108:111], a[204:207], a[152:155], v[108:111]
s_waitcnt vmcnt(9)
v_mfma_f32_16x16x32_bf16 v[112:115], a[208:211], a[152:155], v[112:115]
ds_read_b128 a[152:155], v25 offset:720
v_mfma_f32_16x16x32_bf16 v[32:35], a[212:215], a[128:131], v[32:35]
s_add_u32 s58, s3, 614400
s_nop 0
v_fma_f32 v104, v188, -0.5, v104
v_mfma_f32_16x16x32_bf16 v[36:39], a[216:219], a[128:131], v[36:39]
buffer_load_dwordx4 a[200:203], v13, s[44:47], s58 offen sc1
v_mfma_f32_16x16x32_bf16 v[40:43], a[220:223], a[128:131], v[40:43]
ds_read_b128 a[128:131], v19 offset:800
s_waitcnt lgkmcnt(6)
v_mfma_f32_16x16x32_bf16 v[52:55], a[220:223], a[132:135], v[52:55]
v_fma_f32 v105, v189, -0.5, v105
v_fma_f32 v106, v190, -0.5, v106
v_mfma_f32_16x16x32_bf16 v[48:51], a[216:219], a[132:135], v[48:51]
buffer_load_dwordx4 a[204:207], v13, s[44:47], s58 offen offset:1024 sc1
v_mfma_f32_16x16x32_bf16 v[44:47], a[212:215], a[132:135], v[44:47]
ds_read_b128 a[132:135], v20 offset:800
v_mfma_f32_16x16x32_bf16 v[56:59], a[212:215], a[136:139], v[56:59]
v_fma_f32 v107, v191, -0.5, v107
v_fma_f32 v108, v192, -0.5, v108
v_mfma_f32_16x16x32_bf16 v[60:63], a[216:219], a[136:139], v[60:63]
buffer_load_dwordx4 a[208:211], v13, s[44:47], s58 offen offset:2048 sc1
v_mfma_f32_16x16x32_bf16 v[64:67], a[220:223], a[136:139], v[64:67]
ds_read_b128 a[136:139], v21 offset:800
v_mfma_f32_16x16x32_bf16 v[76:79], a[220:223], a[140:143], v[76:79]
v_fma_f32 v109, v193, -0.5, v109
v_fma_f32 v110, v194, -0.5, v110
v_mfma_f32_16x16x32_bf16 v[72:75], a[216:219], a[140:143], v[72:75]
v_fma_f32 v111, v195, -0.5, v111
v_mfma_f32_16x16x32_bf16 v[68:71], a[212:215], a[140:143], v[68:71]
ds_read_b128 a[140:143], v22 offset:800
s_waitcnt lgkmcnt(4)
v_mfma_f32_16x16x32_bf16 v[80:83], a[212:215], a[144:147], v[80:83]
v_mfma_f32_16x16x32_bf16 v[84:87], a[216:219], a[144:147], v[84:87]
v_mfma_f32_16x16x32_bf16 v[88:91], a[220:223], a[144:147], v[88:91]
ds_read_b128 a[144:147], v23 offset:800
v_mfma_f32_16x16x32_bf16 v[100:103], a[220:223], a[148:151], v[100:103]
v_mfma_f32_16x16x32_bf16 v[96:99], a[216:219], a[148:151], v[96:99]
v_mfma_f32_16x16x32_bf16 v[92:95], a[212:215], a[148:151], v[92:95]
ds_read_b128 a[148:151], v24 offset:800
v_mfma_f32_16x16x32_bf16 v[104:107], a[212:215], a[152:155], v[104:107]
ds_write_b64 v15, a[118:119] offset:33120
v_mfma_f32_16x16x32_bf16 v[108:111], a[216:219], a[152:155], v[108:111]
s_waitcnt vmcnt(9)
v_mfma_f32_16x16x32_bf16 v[112:115], a[220:223], a[152:155], v[112:115]
ds_read_b128 a[152:155], v25 offset:800
s_waitcnt lgkmcnt(5)
v_mfma_f32_16x16x32_bf16 v[32:35], a[224:227], a[128:131], v[32:35]
s_add_u32 s58, s3, 626688
s_nop 3
v_fma_f32 v112, v196, -0.5, v112
v_mfma_f32_16x16x32_bf16 v[36:39], a[228:231], a[128:131], v[36:39]
buffer_load_dwordx4 a[212:215], v13, s[44:47], s58 offen sc1
v_mfma_f32_16x16x32_bf16 v[40:43], a[232:235], a[128:131], v[40:43]
ds_read_b128 a[128:131], v19 offset:864
v_mfma_f32_16x16x32_bf16 v[52:55], a[232:235], a[132:135], v[52:55]
v_fma_f32 v113, v197, -0.5, v113
v_fma_f32 v114, v198, -0.5, v114
v_mfma_f32_16x16x32_bf16 v[48:51], a[228:231], a[132:135], v[48:51]
buffer_load_dwordx4 a[216:219], v13, s[44:47], s58 offen offset:1024 sc1
v_mfma_f32_16x16x32_bf16 v[44:47], a[224:227], a[132:135], v[44:47]
ds_read_b128 a[132:135], v20 offset:864
v_mfma_f32_16x16x32_bf16 v[56:59], a[224:227], a[136:139], v[56:59]
v_fma_f32 v115, v199, -0.5, v115
v_mfma_f32_16x16x32_bf16 v[60:63], a[228:231], a[136:139], v[60:63]
buffer_load_dwordx4 a[220:223], v13, s[44:47], s58 offen offset:2048 sc1
v_mfma_f32_16x16x32_bf16 v[64:67], a[232:235], a[136:139], v[64:67]
ds_read_b128 a[136:139], v21 offset:864
s_waitcnt lgkmcnt(4)
v_mfma_f32_16x16x32_bf16 v[76:79], a[232:235], a[140:143], v[76:79]
s_add_u32 s59, s3, 774144
v_mfma_f32_16x16x32_bf16 v[72:75], a[228:231], a[140:143], v[72:75]
buffer_load_dwordx4 a[108:111], v13, s[44:47], s59 offen sc1
v_mfma_f32_16x16x32_bf16 v[68:71], a[224:227], a[140:143], v[68:71]
ds_read_b128 a[140:143], v22 offset:864
v_mfma_f32_16x16x32_bf16 v[80:83], a[224:227], a[144:147], v[80:83]
v_mfma_f32_16x16x32_bf16 v[84:87], a[228:231], a[144:147], v[84:87]
buffer_load_dwordx4 a[112:115], v13, s[44:47], s59 offen offset:1024 sc1
v_mfma_f32_16x16x32_bf16 v[88:91], a[232:235], a[144:147], v[88:91]
ds_read_b128 a[144:147], v23 offset:864
v_mfma_f32_16x16x32_bf16 v[100:103], a[232:235], a[148:151], v[100:103]
v_mfma_f32_16x16x32_bf16 v[96:99], a[228:231], a[148:151], v[96:99]
buffer_load_dwordx4 a[116:119], v13, s[44:47], s59 offen offset:2048 sc1
v_mfma_f32_16x16x32_bf16 v[92:95], a[224:227], a[148:151], v[92:95]
ds_read_b128 a[148:151], v24 offset:864
s_waitcnt lgkmcnt(4)
v_mfma_f32_16x16x32_bf16 v[104:107], a[224:227], a[152:155], v[104:107]
ds_write_b128 v27, a[120:123] offset:39744
v_mfma_f32_16x16x32_bf16 v[108:111], a[228:231], a[152:155], v[108:111]
s_waitcnt vmcnt(9)
v_mfma_f32_16x16x32_bf16 v[112:115], a[232:235], a[152:155], v[112:115]
ds_read_b128 a[152:155], v25 offset:864
v_mfma_f32_16x16x32_bf16 v[32:35], a[236:239], a[128:131], v[32:35]
s_add_u32 s58, s3, 638976
v_mfma_f32_16x16x32_bf16 v[36:39], a[240:243], a[128:131], v[36:39]
buffer_load_dwordx4 a[224:227], v13, s[44:47], s58 offen sc1
v_mfma_f32_16x16x32_bf16 v[40:43], a[244:247], a[128:131], v[40:43]
ds_read_b128 a[128:131], v19 offset:928
v_mfma_f32_16x16x32_bf16 v[52:55], a[244:247], a[132:135], v[52:55]
v_mfma_f32_16x16x32_bf16 v[48:51], a[240:243], a[132:135], v[48:51]
buffer_load_dwordx4 a[228:231], v13, s[44:47], s58 offen offset:1024 sc1
v_mfma_f32_16x16x32_bf16 v[44:47], a[236:239], a[132:135], v[44:47]
ds_read_b128 a[132:135], v20 offset:928
s_waitcnt lgkmcnt(5)
v_mfma_f32_16x16x32_bf16 v[56:59], a[236:239], a[136:139], v[56:59]
v_mfma_f32_16x16x32_bf16 v[60:63], a[240:243], a[136:139], v[60:63]
buffer_load_dwordx4 a[232:235], v13, s[44:47], s58 offen offset:2048 sc1
v_mfma_f32_16x16x32_bf16 v[64:67], a[244:247], a[136:139], v[64:67]
ds_read_b128 a[136:139], v21 offset:928
v_mfma_f32_16x16x32_bf16 v[76:79], a[244:247], a[140:143], v[76:79]
v_mfma_f32_16x16x32_bf16 v[72:75], a[240:243], a[140:143], v[72:75]
v_mfma_f32_16x16x32_bf16 v[68:71], a[236:239], a[140:143], v[68:71]
ds_read_b128 a[140:143], v22 offset:928
v_mfma_f32_16x16x32_bf16 v[80:83], a[236:239], a[144:147], v[80:83]
v_mfma_f32_16x16x32_bf16 v[84:87], a[240:243], a[144:147], v[84:87]
v_mfma_f32_16x16x32_bf16 v[88:91], a[244:247], a[144:147], v[88:91]
ds_read_b128 a[144:147], v23 offset:928
s_waitcnt lgkmcnt(4)
v_mfma_f32_16x16x32_bf16 v[100:103], a[244:247], a[148:151], v[100:103]
v_mfma_f32_16x16x32_bf16 v[96:99], a[240:243], a[148:151], v[96:99]
v_mfma_f32_16x16x32_bf16 v[92:95], a[236:239], a[148:151], v[92:95]
ds_read_b128 a[148:151], v24 offset:928
v_mfma_f32_16x16x32_bf16 v[104:107], a[236:239], a[152:155], v[104:107]
ds_write_b64 v15, a[124:125] offset:39744
v_mfma_f32_16x16x32_bf16 v[108:111], a[240:243], a[152:155], v[108:111]
s_waitcnt vmcnt(9)
v_mfma_f32_16x16x32_bf16 v[112:115], a[244:247], a[152:155], v[112:115]
ds_read_b128 a[152:155], v25 offset:928
v_mfma_f32_16x16x32_bf16 v[32:35], a[200:203], a[128:131], v[32:35]
s_add_u32 s58, s3, 651264
v_mfma_f32_16x16x32_bf16 v[36:39], a[204:207], a[128:131], v[36:39]
buffer_load_dwordx4 a[236:239], v13, s[44:47], s58 offen sc1
v_mfma_f32_16x16x32_bf16 v[40:43], a[208:211], a[128:131], v[40:43]
ds_read_b128 a[128:131], v19 offset:992
s_waitcnt lgkmcnt(5)
v_mfma_f32_16x16x32_bf16 v[52:55], a[208:211], a[132:135], v[52:55]
v_mfma_f32_16x16x32_bf16 v[48:51], a[204:207], a[132:135], v[48:51]
buffer_load_dwordx4 a[240:243], v13, s[44:47], s58 offen offset:1024 sc1
v_mfma_f32_16x16x32_bf16 v[44:47], a[200:203], a[132:135], v[44:47]
ds_read_b128 a[132:135], v20 offset:992
v_mfma_f32_16x16x32_bf16 v[56:59], a[200:203], a[136:139], v[56:59]
v_mfma_f32_16x16x32_bf16 v[60:63], a[204:207], a[136:139], v[60:63]
buffer_load_dwordx4 a[244:247], v13, s[44:47], s58 offen offset:2048 sc1
v_mfma_f32_16x16x32_bf16 v[64:67], a[208:211], a[136:139], v[64:67]
ds_read_b128 a[136:139], v21 offset:992
v_mfma_f32_16x16x32_bf16 v[76:79], a[208:211], a[140:143], v[76:79]
s_add_u32 s59, s3, 786432
v_mfma_f32_16x16x32_bf16 v[72:75], a[204:207], a[140:143], v[72:75]
buffer_load_dwordx4 a[120:123], v13, s[44:47], s59 offen sc1
v_mfma_f32_16x16x32_bf16 v[68:71], a[200:203], a[140:143], v[68:71]
ds_read_b128 a[140:143], v22 offset:992
s_waitcnt lgkmcnt(4)
v_mfma_f32_16x16x32_bf16 v[80:83], a[200:203], a[144:147], v[80:83]
v_mfma_f32_16x16x32_bf16 v[84:87], a[204:207], a[144:147], v[84:87]
buffer_load_dwordx4 a[156:159], v13, s[44:47], s59 offen offset:1024 sc1
v_mfma_f32_16x16x32_bf16 v[88:91], a[208:211], a[144:147], v[88:91]
ds_read_b128 a[144:147], v23 offset:992
v_mfma_f32_16x16x32_bf16 v[100:103], a[208:211], a[148:151], v[100:103]
v_mfma_f32_16x16x32_bf16 v[96:99], a[204:207], a[148:151], v[96:99]
buffer_load_dwordx4 a[160:163], v13, s[44:47], s59 offen offset:2048 sc1
v_mfma_f32_16x16x32_bf16 v[92:95], a[200:203], a[148:151], v[92:95]
ds_read_b128 a[148:151], v24 offset:992
v_mfma_f32_16x16x32_bf16 v[104:107], a[200:203], a[152:155], v[104:107]
v_mfma_f32_16x16x32_bf16 v[108:111], a[204:207], a[152:155], v[108:111]
s_waitcnt vmcnt(12)
v_mfma_f32_16x16x32_bf16 v[112:115], a[208:211], a[152:155], v[112:115]
ds_read_b128 a[152:155], v25 offset:992
s_waitcnt lgkmcnt(4)
v_mfma_f32_16x16x32_bf16 v[32:35], a[212:215], a[128:131], v[32:35]
v_mfma_f32_16x16x32_bf16 v[36:39], a[216:219], a[128:131], v[36:39]
v_mfma_f32_16x16x32_bf16 v[40:43], a[220:223], a[128:131], v[40:43]
ds_read_b128 a[128:131], v19 offset:1056
v_mfma_f32_16x16x32_bf16 v[52:55], a[220:223], a[132:135], v[52:55]
v_mfma_f32_16x16x32_bf16 v[48:51], a[216:219], a[132:135], v[48:51]
v_mfma_f32_16x16x32_bf16 v[44:47], a[212:215], a[132:135], v[44:47]
ds_read_b128 a[132:135], v20 offset:1056
v_mfma_f32_16x16x32_bf16 v[56:59], a[212:215], a[136:139], v[56:59]
v_mfma_f32_16x16x32_bf16 v[60:63], a[216:219], a[136:139], v[60:63]
v_mfma_f32_16x16x32_bf16 v[64:67], a[220:223], a[136:139], v[64:67]
ds_read_b128 a[136:139], v21 offset:1056
s_waitcnt lgkmcnt(4)
v_mfma_f32_16x16x32_bf16 v[76:79], a[220:223], a[140:143], v[76:79]
s_add_u32 s59, s3, 811008
v_mfma_f32_16x16x32_bf16 v[72:75], a[216:219], a[140:143], v[72:75]
buffer_load_dwordx4 a[200:203], v13, s[44:47], s59 offen sc1
v_mfma_f32_16x16x32_bf16 v[68:71], a[212:215], a[140:143], v[68:71]
ds_read_b128 a[140:143], v22 offset:1056
v_mfma_f32_16x16x32_bf16 v[80:83], a[212:215], a[144:147], v[80:83]
v_mfma_f32_16x16x32_bf16 v[84:87], a[216:219], a[144:147], v[84:87]
buffer_load_dwordx4 a[204:207], v13, s[44:47], s59 offen offset:1024 sc1
v_mfma_f32_16x16x32_bf16 v[88:91], a[220:223], a[144:147], v[88:91]
ds_read_b128 a[144:147], v23 offset:1056
v_mfma_f32_16x16x32_bf16 v[100:103], a[220:223], a[148:151], v[100:103]
v_mfma_f32_16x16x32_bf16 v[96:99], a[216:219], a[148:151], v[96:99]
buffer_load_dwordx4 a[208:211], v13, s[44:47], s59 offen offset:2048 sc1
v_mfma_f32_16x16x32_bf16 v[92:95], a[212:215], a[148:151], v[92:95]
ds_read_b128 a[148:151], v24 offset:1056
s_waitcnt lgkmcnt(4)
v_mfma_f32_16x16x32_bf16 v[104:107], a[212:215], a[152:155], v[104:107]
v_mfma_f32_16x16x32_bf16 v[108:111], a[216:219], a[152:155], v[108:111]
s_waitcnt vmcnt(9)
v_mfma_f32_16x16x32_bf16 v[112:115], a[220:223], a[152:155], v[112:115]
ds_read_b128 a[152:155], v25 offset:1056
v_mfma_f32_16x16x32_bf16 v[32:35], a[224:227], a[128:131], v[32:35]
v_mfma_f32_16x16x32_bf16 v[36:39], a[228:231], a[128:131], v[36:39]
v_mfma_f32_16x16x32_bf16 v[40:43], a[232:235], a[128:131], v[40:43]
ds_read_b128 a[128:131], v19 offset:1120
v_mfma_f32_16x16x32_bf16 v[52:55], a[232:235], a[132:135], v[52:55]
v_mfma_f32_16x16x32_bf16 v[48:51], a[228:231], a[132:135], v[48:51]
v_mfma_f32_16x16x32_bf16 v[44:47], a[224:227], a[132:135], v[44:47]
ds_read_b128 a[132:135], v20 offset:1120
s_waitcnt lgkmcnt(4)
v_mfma_f32_16x16x32_bf16 v[56:59], a[224:227], a[136:139], v[56:59]
v_mfma_f32_16x16x32_bf16 v[60:63], a[228:231], a[136:139], v[60:63]
v_mfma_f32_16x16x32_bf16 v[64:67], a[232:235], a[136:139], v[64:67]
ds_read_b128 a[136:139], v21 offset:1120
v_mfma_f32_16x16x32_bf16 v[76:79], a[232:235], a[140:143], v[76:79]
s_add_u32 s59, s3, 823296
v_mfma_f32_16x16x32_bf16 v[72:75], a[228:231], a[140:143], v[72:75]
buffer_load_dwordx4 a[212:215], v13, s[44:47], s59 offen sc1
v_mfma_f32_16x16x32_bf16 v[68:71], a[224:227], a[140:143], v[68:71]
ds_read_b128 a[140:143], v22 offset:1120
v_mfma_f32_16x16x32_bf16 v[80:83], a[224:227], a[144:147], v[80:83]
v_mfma_f32_16x16x32_bf16 v[84:87], a[228:231], a[144:147], v[84:87]
buffer_load_dwordx4 a[216:219], v13, s[44:47], s59 offen offset:1024 sc1
v_mfma_f32_16x16x32_bf16 v[88:91], a[232:235], a[144:147], v[88:91]
ds_read_b128 a[144:147], v23 offset:1120
s_waitcnt lgkmcnt(4)
v_mfma_f32_16x16x32_bf16 v[100:103], a[232:235], a[148:151], v[100:103]
v_mfma_f32_16x16x32_bf16 v[96:99], a[228:231], a[148:151], v[96:99]
buffer_load_dwordx4 a[220:223], v13, s[44:47], s59 offen offset:2048 sc1
v_mfma_f32_16x16x32_bf16 v[92:95], a[224:227], a[148:151], v[92:95]
ds_read_b128 a[148:151], v24 offset:1120
v_mfma_f32_16x16x32_bf16 v[104:107], a[224:227], a[152:155], v[104:107]
v_mfma_f32_16x16x32_bf16 v[108:111], a[228:231], a[152:155], v[108:111]
s_waitcnt vmcnt(9)
v_mfma_f32_16x16x32_bf16 v[112:115], a[232:235], a[152:155], v[112:115]
ds_read_b128 a[152:155], v25 offset:1120
v_mfma_f32_16x16x32_bf16 v[32:35], a[236:239], a[128:131], v[32:35]
v_mfma_f32_16x16x32_bf16 v[36:39], a[240:243], a[128:131], v[36:39]
v_mfma_f32_16x16x32_bf16 v[40:43], a[244:247], a[128:131], v[40:43]
s_waitcnt lgkmcnt(3)
v_mfma_f32_16x16x32_bf16 v[52:55], a[244:247], a[132:135], v[52:55]
v_mfma_f32_16x16x32_bf16 v[48:51], a[240:243], a[132:135], v[48:51]
v_mfma_f32_16x16x32_bf16 v[44:47], a[236:239], a[132:135], v[44:47]
s_waitcnt lgkmcnt(0)
s_barrier
v_mfma_f32_16x16x32_bf16 v[56:59], a[236:239], a[136:139], v[56:59]
ds_read_b128 a[168:171], v19 offset:46368
v_mfma_f32_16x16x32_bf16 v[60:63], a[240:243], a[136:139], v[60:63]
ds_read_b128 a[172:175], v19 offset:46432
v_mfma_f32_16x16x32_bf16 v[64:67], a[244:247], a[136:139], v[64:67]
ds_read_b128 a[176:179], v19 offset:46496
v_mfma_f32_16x16x32_bf16 v[76:79], a[244:247], a[140:143], v[76:79]
s_add_u32 s59, s3, 835584
v_mfma_f32_16x16x32_bf16 v[72:75], a[240:243], a[140:143], v[72:75]
buffer_load_dwordx4 a[224:227], v13, s[44:47], s59 offen sc1
v_mfma_f32_16x16x32_bf16 v[68:71], a[236:239], a[140:143], v[68:71]
ds_read_b128 a[180:183], v19 offset:46560
v_mfma_f32_16x16x32_bf16 v[80:83], a[236:239], a[144:147], v[80:83]
v_mfma_f32_16x16x32_bf16 v[84:87], a[240:243], a[144:147], v[84:87]
buffer_load_dwordx4 a[228:231], v13, s[44:47], s59 offen offset:1024 sc1
v_mfma_f32_16x16x32_bf16 v[88:91], a[244:247], a[144:147], v[88:91]
ds_read_b128 a[184:187], v19 offset:46624
v_mfma_f32_16x16x32_bf16 v[100:103], a[244:247], a[148:151], v[100:103]
v_mfma_f32_16x16x32_bf16 v[96:99], a[240:243], a[148:151], v[96:99]
buffer_load_dwordx4 a[232:235], v13, s[44:47], s59 offen offset:2048 sc1
v_mfma_f32_16x16x32_bf16 v[92:95], a[236:239], a[148:151], v[92:95]
ds_read_b128 a[188:191], v19 offset:46688
v_mfma_f32_16x16x32_bf16 v[104:107], a[236:239], a[152:155], v[104:107]
v_mfma_f32_16x16x32_bf16 v[108:111], a[240:243], a[152:155], v[108:111]
v_mfma_f32_16x16x32_bf16 v[112:115], a[244:247], a[152:155], v[112:115]
s_waitcnt lgkmcnt(3)
v_mfma_f32_16x16x32_bf16 v[116:119], a[0:3], a[168:171], v[116:119]
s_add_u32 s59, s3, 847872
v_mfma_f32_16x16x32_bf16 v[120:123], a[4:7], a[168:171], v[120:123]
buffer_load_dwordx4 a[236:239], v13, s[44:47], s59 offen sc1
v_mfma_f32_16x16x32_bf16 v[124:127], a[8:11], a[168:171], v[124:127]
ds_read_b128 a[192:195], v19 offset:46768
v_mfma_f32_16x16x32_bf16 v[116:119], a[12:15], a[172:175], v[116:119]
buffer_load_dwordx4 a[240:243], v13, s[44:47], s59 offen offset:1024 sc1
v_mfma_f32_16x16x32_bf16 v[120:123], a[16:19], a[172:175], v[120:123]
buffer_load_dwordx4 a[244:247], v13, s[44:47], s59 offen offset:2048 sc1
v_mfma_f32_16x16x32_bf16 v[124:127], a[20:23], a[172:175], v[124:127]
ds_read_b128 a[196:199], v19 offset:46832
v_mfma_f32_16x16x32_bf16 v[116:119], a[24:27], a[176:179], v[116:119]
s_add_u32 s59, s3, 860160
v_mfma_f32_16x16x32_bf16 v[120:123], a[28:31], a[176:179], v[120:123]
buffer_load_dwordx4 a[128:131], v13, s[44:47], s59 offen sc1
v_mfma_f32_16x16x32_bf16 v[124:127], a[32:35], a[176:179], v[124:127]
ds_read_b128 a[168:171], v19 offset:46896
s_waitcnt lgkmcnt(3)
v_mfma_f32_16x16x32_bf16 v[116:119], a[36:39], a[180:183], v[116:119]
buffer_load_dwordx4 a[132:135], v13, s[44:47], s59 offen offset:1024 sc1
v_mfma_f32_16x16x32_bf16 v[120:123], a[40:43], a[180:183], v[120:123]
buffer_load_dwordx4 a[136:139], v13, s[44:47], s59 offen offset:2048 sc1
v_mfma_f32_16x16x32_bf16 v[124:127], a[44:47], a[180:183], v[124:127]
ds_read_b128 a[172:175], v19 offset:46960
v_mfma_f32_16x16x32_bf16 v[116:119], a[48:51], a[184:187], v[116:119]
s_add_u32 s59, s3, 872448
v_mfma_f32_16x16x32_bf16 v[120:123], a[52:55], a[184:187], v[120:123]
buffer_load_dwordx4 a[140:143], v13, s[44:47], s59 offen sc1
v_mfma_f32_16x16x32_bf16 v[124:127], a[56:59], a[184:187], v[124:127]
ds_read_b128 a[176:179], v19 offset:47024
v_mfma_f32_16x16x32_bf16 v[116:119], a[60:63], a[188:191], v[116:119]
buffer_load_dwordx4 a[144:147], v13, s[44:47], s59 offen offset:1024 sc1
v_mfma_f32_16x16x32_bf16 v[120:123], a[64:67], a[188:191], v[120:123]
buffer_load_dwordx4 a[148:151], v13, s[44:47], s59 offen offset:2048 sc1
v_mfma_f32_16x16x32_bf16 v[124:127], a[68:71], a[188:191], v[124:127]
ds_read_b128 a[180:183], v19 offset:47088
s_waitcnt lgkmcnt(4)
v_mfma_f32_16x16x32_bf16 v[116:119], a[72:75], a[192:195], v[116:119]
v_mfma_f32_16x16x32_bf16 v[120:123], a[76:79], a[192:195], v[120:123]
v_mfma_f32_16x16x32_bf16 v[124:127], a[80:83], a[192:195], v[124:127]
ds_read_b128 a[184:187], v19 offset:47168
v_mfma_f32_16x16x32_bf16 v[116:119], a[84:87], a[196:199], v[116:119]
v_mfma_f32_16x16x32_bf16 v[120:123], a[88:91], a[196:199], v[120:123]
v_mfma_f32_16x16x32_bf16 v[124:127], a[92:95], a[196:199], v[124:127]
ds_read_b128 a[188:191], v19 offset:47232
s_waitcnt lgkmcnt(4)
v_mfma_f32_16x16x32_bf16 v[116:119], a[96:99], a[168:171], v[116:119]
v_mfma_f32_16x16x32_bf16 v[120:123], a[100:103], a[168:171], v[120:123]
v_mfma_f32_16x16x32_bf16 v[124:127], a[104:107], a[168:171], v[124:127]
ds_read_b128 a[192:195], v19 offset:47296
v_mfma_f32_16x16x32_bf16 v[116:119], a[108:111], a[172:175], v[116:119]
v_mfma_f32_16x16x32_bf16 v[120:123], a[112:115], a[172:175], v[120:123]
v_mfma_f32_16x16x32_bf16 v[124:127], a[116:119], a[172:175], v[124:127]
ds_read_b128 a[196:199], v19 offset:47360
s_waitcnt vmcnt(20) lgkmcnt(4)
v_mfma_f32_16x16x32_bf16 v[116:119], a[120:123], a[176:179], v[116:119]
s_waitcnt vmcnt(19)
v_mfma_f32_16x16x32_bf16 v[120:123], a[156:159], a[176:179], v[120:123]
s_waitcnt vmcnt(18)
v_mfma_f32_16x16x32_bf16 v[124:127], a[160:163], a[176:179], v[124:127]
ds_read_b128 a[168:171], v19 offset:47424
v_mfma_f32_16x16x32_bf16 v[116:119], a[164:167], a[180:183], v[116:119]
v_mfma_f32_16x16x32_bf16 v[120:123], a[248:251], a[180:183], v[120:123]
v_mfma_f32_16x16x32_bf16 v[124:127], a[252:255], a[180:183], v[124:127]
ds_read_b128 a[172:175], v19 offset:47488
s_waitcnt vmcnt(17) lgkmcnt(4)
v_mfma_f32_16x16x32_bf16 v[116:119], a[200:203], a[184:187], v[116:119]
s_waitcnt vmcnt(16)
v_mfma_f32_16x16x32_bf16 v[120:123], a[204:207], a[184:187], v[120:123]
s_waitcnt vmcnt(15)
v_mfma_f32_16x16x32_bf16 v[124:127], a[208:211], a[184:187], v[124:127]
ds_read_b128 a[176:179], v20 offset:46368
s_waitcnt vmcnt(14)
v_mfma_f32_16x16x32_bf16 v[116:119], a[212:215], a[188:191], v[116:119]
s_waitcnt vmcnt(13)
v_mfma_f32_16x16x32_bf16 v[120:123], a[216:219], a[188:191], v[120:123]
s_waitcnt vmcnt(12)
v_mfma_f32_16x16x32_bf16 v[124:127], a[220:223], a[188:191], v[124:127]
ds_read_b128 a[180:183], v20 offset:46432
s_waitcnt vmcnt(11) lgkmcnt(4)
v_mfma_f32_16x16x32_bf16 v[116:119], a[224:227], a[192:195], v[116:119]
s_waitcnt vmcnt(10)
v_mfma_f32_16x16x32_bf16 v[120:123], a[228:231], a[192:195], v[120:123]
s_waitcnt vmcnt(9)
v_mfma_f32_16x16x32_bf16 v[124:127], a[232:235], a[192:195], v[124:127]
ds_read_b128 a[184:187], v20 offset:46496
s_waitcnt vmcnt(8)
v_mfma_f32_16x16x32_bf16 v[116:119], a[236:239], a[196:199], v[116:119]
s_waitcnt vmcnt(7)
v_mfma_f32_16x16x32_bf16 v[120:123], a[240:243], a[196:199], v[120:123]
s_waitcnt vmcnt(6)
v_mfma_f32_16x16x32_bf16 v[124:127], a[244:247], a[196:199], v[124:127]
ds_read_b128 a[188:191], v20 offset:46560
s_waitcnt vmcnt(5) lgkmcnt(4)
v_mfma_f32_16x16x32_bf16 v[116:119], a[128:131], a[168:171], v[116:119]
s_waitcnt vmcnt(4)
v_mfma_f32_16x16x32_bf16 v[120:123], a[132:135], a[168:171], v[120:123]
s_waitcnt vmcnt(3)
v_mfma_f32_16x16x32_bf16 v[124:127], a[136:139], a[168:171], v[124:127]
ds_read_b128 a[192:195], v20 offset:46624
s_waitcnt vmcnt(2)
v_mfma_f32_16x16x32_bf16 v[116:119], a[140:143], a[172:175], v[116:119]
s_waitcnt vmcnt(1)
v_mfma_f32_16x16x32_bf16 v[120:123], a[144:147], a[172:175], v[120:123]
s_waitcnt vmcnt(0)
v_mfma_f32_16x16x32_bf16 v[124:127], a[148:151], a[172:175], v[124:127]
ds_read_b128 a[196:199], v20 offset:46688
s_waitcnt lgkmcnt(4)
v_mfma_f32_16x16x32_bf16 v[128:131], a[0:3], a[176:179], v[128:131]
v_mfma_f32_16x16x32_bf16 v[132:135], a[4:7], a[176:179], v[132:135]
v_mfma_f32_16x16x32_bf16 v[136:139], a[8:11], a[176:179], v[136:139]
ds_read_b128 a[168:171], v20 offset:46768
v_mfma_f32_16x16x32_bf16 v[128:131], a[12:15], a[180:183], v[128:131]
v_fma_f32 v214, v116, 0.5, v32
v_fma_f32 v215, v117, 0.5, v33
v_mfma_f32_16x16x32_bf16 v[132:135], a[16:19], a[180:183], v[132:135]
v_cvt_pk_bf16_f32 v208, v214, v215
v_mfma_f32_16x16x32_bf16 v[136:139], a[20:23], a[180:183], v[136:139]
ds_read_b128 a[172:175], v20 offset:46832
s_waitcnt lgkmcnt(4)
v_mfma_f32_16x16x32_bf16 v[128:131], a[24:27], a[184:187], v[128:131]
v_fma_f32 v216, v118, 0.5, v34
v_mfma_f32_16x16x32_bf16 v[132:135], a[28:31], a[184:187], v[132:135]
v_fma_f32 v217, v119, 0.5, v35
v_cvt_pk_bf16_f32 v209, v216, v217
v_mfma_f32_16x16x32_bf16 v[136:139], a[32:35], a[184:187], v[136:139]
ds_read_b128 a[176:179], v20 offset:46896
v_mfma_f32_16x16x32_bf16 v[128:131], a[36:39], a[188:191], v[128:131]
v_fma_f32 v214, v120, 0.5, v36
v_mfma_f32_16x16x32_bf16 v[132:135], a[40:43], a[188:191], v[132:135]
v_fma_f32 v215, v121, 0.5, v37
v_mfma_f32_16x16x32_bf16 v[136:139], a[44:47], a[188:191], v[136:139]
ds_read_b128 a[180:183], v20 offset:46960
s_waitcnt lgkmcnt(4)
v_mfma_f32_16x16x32_bf16 v[128:131], a[48:51], a[192:195], v[128:131]
v_cvt_pk_bf16_f32 v210, v214, v215
v_mfma_f32_16x16x32_bf16 v[132:135], a[52:55], a[192:195], v[132:135]
v_fma_f32 v216, v122, 0.5, v38
v_fma_f32 v217, v123, 0.5, v39
v_mfma_f32_16x16x32_bf16 v[136:139], a[56:59], a[192:195], v[136:139]
ds_read_b128 a[184:187], v20 offset:47024
v_mfma_f32_16x16x32_bf16 v[128:131], a[60:63], a[196:199], v[128:131]
v_cvt_pk_bf16_f32 v211, v216, v217
v_mfma_f32_16x16x32_bf16 v[132:135], a[64:67], a[196:199], v[132:135]
v_fma_f32 v214, v124, 0.5, v40
v_mfma_f32_16x16x32_bf16 v[136:139], a[68:71], a[196:199], v[136:139]
ds_read_b128 a[188:191], v20 offset:47088
s_waitcnt lgkmcnt(4)
v_mfma_f32_16x16x32_bf16 v[128:131], a[72:75], a[168:171], v[128:131]
v_fma_f32 v215, v125, 0.5, v41
v_cvt_pk_bf16_f32 v212, v214, v215
v_mfma_f32_16x16x32_bf16 v[132:135], a[76:79], a[168:171], v[132:135]
v_fma_f32 v216, v126, 0.5, v42
v_mfma_f32_16x16x32_bf16 v[136:139], a[80:83], a[168:171], v[136:139]
ds_read_b128 a[192:195], v20 offset:47168
v_mfma_f32_16x16x32_bf16 v[128:131], a[84:87], a[172:175], v[128:131]
v_fma_f32 v217, v127, 0.5, v43
v_mfma_f32_16x16x32_bf16 v[132:135], a[88:91], a[172:175], v[132:135]
v_cvt_pk_bf16_f32 v213, v216, v217
v_mfma_f32_16x16x32_bf16 v[136:139], a[92:95], a[172:175], v[136:139]
ds_read_b128 a[196:199], v20 offset:47232
s_waitcnt lgkmcnt(4)
v_mfma_f32_16x16x32_bf16 v[128:131], a[96:99], a[176:179], v[128:131]
buffer_store_dwordx4 v[208:211], v200, s[36:39], s56 offen
v_add_u32 v6, v200, v30
v_mfma_f32_16x16x32_bf16 v[132:135], a[100:103], a[176:179], v[132:135]
buffer_store_dwordx2 v[212:213], v6, s[36:39], s56 offen
v_mfma_f32_16x16x32_bf16 v[136:139], a[104:107], a[176:179], v[136:139]
ds_read_b128 a[168:171], v20 offset:47296
v_mfma_f32_16x16x32_bf16 v[128:131], a[108:111], a[180:183], v[128:131]
v_fma_f32 v226, v116, -0.5, v32
v_mfma_f32_16x16x32_bf16 v[132:135], a[112:115], a[180:183], v[132:135]
v_fma_f32 v227, v117, -0.5, v33
v_cvt_pk_bf16_f32 v220, v226, v227
v_mfma_f32_16x16x32_bf16 v[136:139], a[116:119], a[180:183], v[136:139]
ds_read_b128 a[172:175], v20 offset:47360
s_waitcnt lgkmcnt(4)
v_mfma_f32_16x16x32_bf16 v[128:131], a[120:123], a[184:187], v[128:131]
v_fma_f32 v228, v118, -0.5, v34
v_mfma_f32_16x16x32_bf16 v[132:135], a[156:159], a[184:187], v[132:135]
v_fma_f32 v229, v119, -0.5, v35
v_mfma_f32_16x16x32_bf16 v[136:139], a[160:163], a[184:187], v[136:139]
ds_read_b128 a[176:179], v20 offset:47424
v_mfma_f32_16x16x32_bf16 v[128:131], a[164:167], a[188:191], v[128:131]
v_cvt_pk_bf16_f32 v221, v228, v229
v_mfma_f32_16x16x32_bf16 v[132:135], a[248:251], a[188:191], v[132:135]
v_fma_f32 v226, v120, -0.5, v36
v_fma_f32 v227, v121, -0.5, v37
v_mfma_f32_16x16x32_bf16 v[136:139], a[252:255], a[188:191], v[136:139]
ds_read_b128 a[180:183], v20 offset:47488
s_waitcnt lgkmcnt(4)
v_mfma_f32_16x16x32_bf16 v[128:131], a[200:203], a[192:195], v[128:131]
v_cvt_pk_bf16_f32 v222, v226, v227
v_mfma_f32_16x16x32_bf16 v[132:135], a[204:207], a[192:195], v[132:135]
v_fma_f32 v228, v122, -0.5, v38
v_mfma_f32_16x16x32_bf16 v[136:139], a[208:211], a[192:195], v[136:139]
ds_read_b128 a[184:187], v21 offset:46368
v_mfma_f32_16x16x32_bf16 v[128:131], a[212:215], a[196:199], v[128:131]
v_fma_f32 v229, v123, -0.5, v39
v_cvt_pk_bf16_f32 v223, v228, v229
v_mfma_f32_16x16x32_bf16 v[132:135], a[216:219], a[196:199], v[132:135]
v_fma_f32 v226, v124, -0.5, v40
v_mfma_f32_16x16x32_bf16 v[136:139], a[220:223], a[196:199], v[136:139]
ds_read_b128 a[188:191], v21 offset:46432
s_waitcnt lgkmcnt(4)
v_mfma_f32_16x16x32_bf16 v[128:131], a[224:227], a[168:171], v[128:131]
v_fma_f32 v227, v125, -0.5, v41
v_mfma_f32_16x16x32_bf16 v[132:135], a[228:231], a[168:171], v[132:135]
v_cvt_pk_bf16_f32 v224, v226, v227
v_mfma_f32_16x16x32_bf16 v[136:139], a[232:235], a[168:171], v[136:139]
ds_read_b128 a[192:195], v21 offset:46496
v_mfma_f32_16x16x32_bf16 v[128:131], a[236:239], a[172:175], v[128:131]
v_fma_f32 v228, v126, -0.5, v42
v_fma_f32 v229, v127, -0.5, v43
v_mfma_f32_16x16x32_bf16 v[132:135], a[240:243], a[172:175], v[132:135]
v_cvt_pk_bf16_f32 v225, v228, v229
v_mfma_f32_16x16x32_bf16 v[136:139], a[244:247], a[172:175], v[136:139]
ds_read_b128 a[196:199], v21 offset:46560
s_waitcnt lgkmcnt(4)
v_mfma_f32_16x16x32_bf16 v[128:131], a[128:131], a[176:179], v[128:131]
buffer_store_dwordx4 v[220:223], v200, s[36:39], s57 offen
v_mfma_f32_16x16x32_bf16 v[132:135], a[132:135], a[176:179], v[132:135]
buffer_store_dwordx2 v[224:225], v6, s[36:39], s57 offen
v_mfma_f32_16x16x32_bf16 v[136:139], a[136:139], a[176:179], v[136:139]
ds_read_b128 a[168:171], v21 offset:46624
v_mfma_f32_16x16x32_bf16 v[128:131], a[140:143], a[180:183], v[128:131]
v_mfma_f32_16x16x32_bf16 v[132:135], a[144:147], a[180:183], v[132:135]
v_mfma_f32_16x16x32_bf16 v[136:139], a[148:151], a[180:183], v[136:139]
ds_read_b128 a[172:175], v21 offset:46688
s_waitcnt lgkmcnt(4)
v_mfma_f32_16x16x32_bf16 v[140:143], a[0:3], a[184:187], v[140:143]
v_mfma_f32_16x16x32_bf16 v[144:147], a[4:7], a[184:187], v[144:147]
v_mfma_f32_16x16x32_bf16 v[148:151], a[8:11], a[184:187], v[148:151]
ds_read_b128 a[176:179], v21 offset:46768
v_mfma_f32_16x16x32_bf16 v[140:143], a[12:15], a[188:191], v[140:143]
v_fma_f32 v238, v128, 0.5, v44
v_fma_f32 v239, v129, 0.5, v45
v_mfma_f32_16x16x32_bf16 v[144:147], a[16:19], a[188:191], v[144:147]
v_cvt_pk_bf16_f32 v232, v238, v239
v_mfma_f32_16x16x32_bf16 v[148:151], a[20:23], a[188:191], v[148:151]
ds_read_b128 a[180:183], v21 offset:46832
s_waitcnt lgkmcnt(4)
v_mfma_f32_16x16x32_bf16 v[140:143], a[24:27], a[192:195], v[140:143]
v_fma_f32 v240, v130, 0.5, v46
v_mfma_f32_16x16x32_bf16 v[144:147], a[28:31], a[192:195], v[144:147]
v_fma_f32 v241, v131, 0.5, v47
v_cvt_pk_bf16_f32 v233, v240, v241
v_mfma_f32_16x16x32_bf16 v[148:151], a[32:35], a[192:195], v[148:151]
ds_read_b128 a[184:187], v21 offset:46896
v_mfma_f32_16x16x32_bf16 v[140:143], a[36:39], a[196:199], v[140:143]
v_fma_f32 v238, v132, 0.5, v48
v_mfma_f32_16x16x32_bf16 v[144:147], a[40:43], a[196:199], v[144:147]
v_fma_f32 v239, v133, 0.5, v49
v_mfma_f32_16x16x32_bf16 v[148:151], a[44:47], a[196:199], v[148:151]
ds_read_b128 a[188:191], v21 offset:46960
s_waitcnt lgkmcnt(4)
v_mfma_f32_16x16x32_bf16 v[140:143], a[48:51], a[168:171], v[140:143]
v_cvt_pk_bf16_f32 v234, v238, v239
v_mfma_f32_16x16x32_bf16 v[144:147], a[52:55], a[168:171], v[144:147]
v_fma_f32 v240, v134, 0.5, v50
v_fma_f32 v241, v135, 0.5, v51
v_mfma_f32_16x16x32_bf16 v[148:151], a[56:59], a[168:171], v[148:151]
ds_read_b128 a[192:195], v21 offset:47024
v_mfma_f32_16x16x32_bf16 v[140:143], a[60:63], a[172:175], v[140:143]
v_cvt_pk_bf16_f32 v235, v240, v241
v_mfma_f32_16x16x32_bf16 v[144:147], a[64:67], a[172:175], v[144:147]
v_fma_f32 v238, v136, 0.5, v52
v_mfma_f32_16x16x32_bf16 v[148:151], a[68:71], a[172:175], v[148:151]
ds_read_b128 a[196:199], v21 offset:47088
s_waitcnt lgkmcnt(4)
v_mfma_f32_16x16x32_bf16 v[140:143], a[72:75], a[176:179], v[140:143]
v_fma_f32 v239, v137, 0.5, v53
v_cvt_pk_bf16_f32 v236, v238, v239
v_mfma_f32_16x16x32_bf16 v[144:147], a[76:79], a[176:179], v[144:147]
v_fma_f32 v240, v138, 0.5, v54
v_mfma_f32_16x16x32_bf16 v[148:151], a[80:83], a[176:179], v[148:151]
ds_read_b128 a[168:171], v21 offset:47168
v_mfma_f32_16x16x32_bf16 v[140:143], a[84:87], a[180:183], v[140:143]
v_fma_f32 v241, v139, 0.5, v55
v_mfma_f32_16x16x32_bf16 v[144:147], a[88:91], a[180:183], v[144:147]
v_cvt_pk_bf16_f32 v237, v240, v241
v_mfma_f32_16x16x32_bf16 v[148:151], a[92:95], a[180:183], v[148:151]
ds_read_b128 a[172:175], v21 offset:47232
s_waitcnt lgkmcnt(4)
v_mfma_f32_16x16x32_bf16 v[140:143], a[96:99], a[184:187], v[140:143]
buffer_store_dwordx4 v[232:235], v201, s[36:39], s56 offen
v_add_u32 v7, v201, v30
v_mfma_f32_16x16x32_bf16 v[144:147], a[100:103], a[184:187], v[144:147]
buffer_store_dwordx2 v[236:237], v7, s[36:39], s56 offen
v_mfma_f32_16x16x32_bf16 v[148:151], a[104:107], a[184:187], v[148:151]
ds_read_b128 a[176:179], v21 offset:47296
v_mfma_f32_16x16x32_bf16 v[140:143], a[108:111], a[188:191], v[140:143]
v_fma_f32 v250, v128, -0.5, v44
v_mfma_f32_16x16x32_bf16 v[144:147], a[112:115], a[188:191], v[144:147]
v_fma_f32 v251, v129, -0.5, v45
v_cvt_pk_bf16_f32 v244, v250, v251
v_mfma_f32_16x16x32_bf16 v[148:151], a[116:119], a[188:191], v[148:151]
ds_read_b128 a[180:183], v21 offset:47360
s_waitcnt lgkmcnt(4)
v_mfma_f32_16x16x32_bf16 v[140:143], a[120:123], a[192:195], v[140:143]
v_fma_f32 v252, v130, -0.5, v46
v_mfma_f32_16x16x32_bf16 v[144:147], a[156:159], a[192:195], v[144:147]
v_fma_f32 v253, v131, -0.5, v47
v_mfma_f32_16x16x32_bf16 v[148:151], a[160:163], a[192:195], v[148:151]
ds_read_b128 a[184:187], v21 offset:47424
v_mfma_f32_16x16x32_bf16 v[140:143], a[164:167], a[196:199], v[140:143]
v_cvt_pk_bf16_f32 v245, v252, v253
v_mfma_f32_16x16x32_bf16 v[144:147], a[248:251], a[196:199], v[144:147]
v_fma_f32 v250, v132, -0.5, v48
v_fma_f32 v251, v133, -0.5, v49
v_mfma_f32_16x16x32_bf16 v[148:151], a[252:255], a[196:199], v[148:151]
ds_read_b128 a[188:191], v21 offset:47488
s_waitcnt lgkmcnt(4)
v_mfma_f32_16x16x32_bf16 v[140:143], a[200:203], a[168:171], v[140:143]
v_cvt_pk_bf16_f32 v246, v250, v251
v_mfma_f32_16x16x32_bf16 v[144:147], a[204:207], a[168:171], v[144:147]
v_fma_f32 v252, v134, -0.5, v50
v_mfma_f32_16x16x32_bf16 v[148:151], a[208:211], a[168:171], v[148:151]
ds_read_b128 a[192:195], v22 offset:46368
v_mfma_f32_16x16x32_bf16 v[140:143], a[212:215], a[172:175], v[140:143]
v_fma_f32 v253, v135, -0.5, v51
v_cvt_pk_bf16_f32 v247, v252, v253
v_mfma_f32_16x16x32_bf16 v[144:147], a[216:219], a[172:175], v[144:147]
v_fma_f32 v250, v136, -0.5, v52
v_mfma_f32_16x16x32_bf16 v[148:151], a[220:223], a[172:175], v[148:151]
ds_read_b128 a[196:199], v22 offset:46432
s_waitcnt lgkmcnt(4)
v_mfma_f32_16x16x32_bf16 v[140:143], a[224:227], a[176:179], v[140:143]
v_fma_f32 v251, v137, -0.5, v53
v_mfma_f32_16x16x32_bf16 v[144:147], a[228:231], a[176:179], v[144:147]
v_cvt_pk_bf16_f32 v248, v250, v251
v_mfma_f32_16x16x32_bf16 v[148:151], a[232:235], a[176:179], v[148:151]
ds_read_b128 a[168:171], v22 offset:46496
v_mfma_f32_16x16x32_bf16 v[140:143], a[236:239], a[180:183], v[140:143]
v_fma_f32 v252, v138, -0.5, v54
v_fma_f32 v253, v139, -0.5, v55
v_mfma_f32_16x16x32_bf16 v[144:147], a[240:243], a[180:183], v[144:147]
v_cvt_pk_bf16_f32 v249, v252, v253
v_mfma_f32_16x16x32_bf16 v[148:151], a[244:247], a[180:183], v[148:151]
ds_read_b128 a[172:175], v22 offset:46560
s_waitcnt lgkmcnt(4)
v_mfma_f32_16x16x32_bf16 v[140:143], a[128:131], a[184:187], v[140:143]
buffer_store_dwordx4 v[244:247], v201, s[36:39], s57 offen
v_mfma_f32_16x16x32_bf16 v[144:147], a[132:135], a[184:187], v[144:147]
buffer_store_dwordx2 v[248:249], v7, s[36:39], s57 offen
v_mfma_f32_16x16x32_bf16 v[148:151], a[136:139], a[184:187], v[148:151]
ds_read_b128 a[176:179], v22 offset:46624
v_mfma_f32_16x16x32_bf16 v[140:143], a[140:143], a[188:191], v[140:143]
v_mfma_f32_16x16x32_bf16 v[144:147], a[144:147], a[188:191], v[144:147]
v_mfma_f32_16x16x32_bf16 v[148:151], a[148:151], a[188:191], v[148:151]
ds_read_b128 a[180:183], v22 offset:46688
s_waitcnt lgkmcnt(4)
v_mfma_f32_16x16x32_bf16 v[152:155], a[0:3], a[192:195], v[152:155]
v_mfma_f32_16x16x32_bf16 v[156:159], a[4:7], a[192:195], v[156:159]
v_mfma_f32_16x16x32_bf16 v[160:163], a[8:11], a[192:195], v[160:163]
ds_read_b128 a[184:187], v22 offset:46768
v_mfma_f32_16x16x32_bf16 v[152:155], a[12:15], a[196:199], v[152:155]
v_fma_f32 v214, v140, 0.5, v56
v_fma_f32 v215, v141, 0.5, v57
v_mfma_f32_16x16x32_bf16 v[156:159], a[16:19], a[196:199], v[156:159]
v_cvt_pk_bf16_f32 v208, v214, v215
v_mfma_f32_16x16x32_bf16 v[160:163], a[20:23], a[196:199], v[160:163]
ds_read_b128 a[188:191], v22 offset:46832
s_waitcnt lgkmcnt(4)
v_mfma_f32_16x16x32_bf16 v[152:155], a[24:27], a[168:171], v[152:155]
v_fma_f32 v216, v142, 0.5, v58
v_mfma_f32_16x16x32_bf16 v[156:159], a[28:31], a[168:171], v[156:159]
v_fma_f32 v217, v143, 0.5, v59
v_cvt_pk_bf16_f32 v209, v216, v217
v_mfma_f32_16x16x32_bf16 v[160:163], a[32:35], a[168:171], v[160:163]
ds_read_b128 a[192:195], v22 offset:46896
v_mfma_f32_16x16x32_bf16 v[152:155], a[36:39], a[172:175], v[152:155]
v_fma_f32 v214, v144, 0.5, v60
v_mfma_f32_16x16x32_bf16 v[156:159], a[40:43], a[172:175], v[156:159]
v_fma_f32 v215, v145, 0.5, v61
v_mfma_f32_16x16x32_bf16 v[160:163], a[44:47], a[172:175], v[160:163]
ds_read_b128 a[196:199], v22 offset:46960
s_waitcnt lgkmcnt(4)
v_mfma_f32_16x16x32_bf16 v[152:155], a[48:51], a[176:179], v[152:155]
v_cvt_pk_bf16_f32 v210, v214, v215
v_mfma_f32_16x16x32_bf16 v[156:159], a[52:55], a[176:179], v[156:159]
v_fma_f32 v216, v146, 0.5, v62
v_fma_f32 v217, v147, 0.5, v63
v_mfma_f32_16x16x32_bf16 v[160:163], a[56:59], a[176:179], v[160:163]
ds_read_b128 a[168:171], v22 offset:47024
v_mfma_f32_16x16x32_bf16 v[152:155], a[60:63], a[180:183], v[152:155]
v_cvt_pk_bf16_f32 v211, v216, v217
v_mfma_f32_16x16x32_bf16 v[156:159], a[64:67], a[180:183], v[156:159]
v_fma_f32 v214, v148, 0.5, v64
v_mfma_f32_16x16x32_bf16 v[160:163], a[68:71], a[180:183], v[160:163]
ds_read_b128 a[172:175], v22 offset:47088
s_waitcnt lgkmcnt(4)
v_mfma_f32_16x16x32_bf16 v[152:155], a[72:75], a[184:187], v[152:155]
v_fma_f32 v215, v149, 0.5, v65
v_cvt_pk_bf16_f32 v212, v214, v215
v_mfma_f32_16x16x32_bf16 v[156:159], a[76:79], a[184:187], v[156:159]
v_fma_f32 v216, v150, 0.5, v66
v_mfma_f32_16x16x32_bf16 v[160:163], a[80:83], a[184:187], v[160:163]
ds_read_b128 a[176:179], v22 offset:47168
v_mfma_f32_16x16x32_bf16 v[152:155], a[84:87], a[188:191], v[152:155]
v_fma_f32 v217, v151, 0.5, v67
v_mfma_f32_16x16x32_bf16 v[156:159], a[88:91], a[188:191], v[156:159]
v_cvt_pk_bf16_f32 v213, v216, v217
v_mfma_f32_16x16x32_bf16 v[160:163], a[92:95], a[188:191], v[160:163]
ds_read_b128 a[180:183], v22 offset:47232
s_waitcnt lgkmcnt(4)
v_mfma_f32_16x16x32_bf16 v[152:155], a[96:99], a[192:195], v[152:155]
buffer_store_dwordx4 v[208:211], v202, s[36:39], s56 offen
v_add_u32 v8, v202, v30
v_mfma_f32_16x16x32_bf16 v[156:159], a[100:103], a[192:195], v[156:159]
buffer_store_dwordx2 v[212:213], v8, s[36:39], s56 offen
v_mfma_f32_16x16x32_bf16 v[160:163], a[104:107], a[192:195], v[160:163]
ds_read_b128 a[184:187], v22 offset:47296
v_mfma_f32_16x16x32_bf16 v[152:155], a[108:111], a[196:199], v[152:155]
v_fma_f32 v226, v140, -0.5, v56
v_mfma_f32_16x16x32_bf16 v[156:159], a[112:115], a[196:199], v[156:159]
v_fma_f32 v227, v141, -0.5, v57
v_cvt_pk_bf16_f32 v220, v226, v227
v_mfma_f32_16x16x32_bf16 v[160:163], a[116:119], a[196:199], v[160:163]
ds_read_b128 a[188:191], v22 offset:47360
s_waitcnt lgkmcnt(4)
v_mfma_f32_16x16x32_bf16 v[152:155], a[120:123], a[168:171], v[152:155]
v_fma_f32 v228, v142, -0.5, v58
v_mfma_f32_16x16x32_bf16 v[156:159], a[156:159], a[168:171], v[156:159]
v_fma_f32 v229, v143, -0.5, v59
v_mfma_f32_16x16x32_bf16 v[160:163], a[160:163], a[168:171], v[160:163]
ds_read_b128 a[192:195], v22 offset:47424
v_mfma_f32_16x16x32_bf16 v[152:155], a[164:167], a[172:175], v[152:155]
v_cvt_pk_bf16_f32 v221, v228, v229
v_mfma_f32_16x16x32_bf16 v[156:159], a[248:251], a[172:175], v[156:159]
v_fma_f32 v226, v144, -0.5, v60
v_fma_f32 v227, v145, -0.5, v61
v_mfma_f32_16x16x32_bf16 v[160:163], a[252:255], a[172:175], v[160:163]
ds_read_b128 a[196:199], v22 offset:47488
s_waitcnt lgkmcnt(4)
v_mfma_f32_16x16x32_bf16 v[152:155], a[200:203], a[176:179], v[152:155]
v_cvt_pk_bf16_f32 v222, v226, v227
v_mfma_f32_16x16x32_bf16 v[156:159], a[204:207], a[176:179], v[156:159]
v_fma_f32 v228, v146, -0.5, v62
v_mfma_f32_16x16x32_bf16 v[160:163], a[208:211], a[176:179], v[160:163]
ds_read_b128 a[168:171], v23 offset:46368
v_mfma_f32_16x16x32_bf16 v[152:155], a[212:215], a[180:183], v[152:155]
v_fma_f32 v229, v147, -0.5, v63
v_cvt_pk_bf16_f32 v223, v228, v229
v_mfma_f32_16x16x32_bf16 v[156:159], a[216:219], a[180:183], v[156:159]
v_fma_f32 v226, v148, -0.5, v64
v_mfma_f32_16x16x32_bf16 v[160:163], a[220:223], a[180:183], v[160:163]
ds_read_b128 a[172:175], v23 offset:46432
s_waitcnt lgkmcnt(4)
v_mfma_f32_16x16x32_bf16 v[152:155], a[224:227], a[184:187], v[152:155]
v_fma_f32 v227, v149, -0.5, v65
v_mfma_f32_16x16x32_bf16 v[156:159], a[228:231], a[184:187], v[156:159]
v_cvt_pk_bf16_f32 v224, v226, v227
v_mfma_f32_16x16x32_bf16 v[160:163], a[232:235], a[184:187], v[160:163]
ds_read_b128 a[176:179], v23 offset:46496
v_mfma_f32_16x16x32_bf16 v[152:155], a[236:239], a[188:191], v[152:155]
v_fma_f32 v228, v150, -0.5, v66
v_fma_f32 v229, v151, -0.5, v67
v_mfma_f32_16x16x32_bf16 v[156:159], a[240:243], a[188:191], v[156:159]
v_cvt_pk_bf16_f32 v225, v228, v229
v_mfma_f32_16x16x32_bf16 v[160:163], a[244:247], a[188:191], v[160:163]
ds_read_b128 a[180:183], v23 offset:46560
s_waitcnt lgkmcnt(4)
v_mfma_f32_16x16x32_bf16 v[152:155], a[128:131], a[192:195], v[152:155]
buffer_store_dwordx4 v[220:223], v202, s[36:39], s57 offen
v_mfma_f32_16x16x32_bf16 v[156:159], a[132:135], a[192:195], v[156:159]
buffer_store_dwordx2 v[224:225], v8, s[36:39], s57 offen
v_mfma_f32_16x16x32_bf16 v[160:163], a[136:139], a[192:195], v[160:163]
ds_read_b128 a[184:187], v23 offset:46624
v_mfma_f32_16x16x32_bf16 v[152:155], a[140:143], a[196:199], v[152:155]
v_mfma_f32_16x16x32_bf16 v[156:159], a[144:147], a[196:199], v[156:159]
v_mfma_f32_16x16x32_bf16 v[160:163], a[148:151], a[196:199], v[160:163]
ds_read_b128 a[188:191], v23 offset:46688
s_waitcnt lgkmcnt(4)
v_mfma_f32_16x16x32_bf16 v[164:167], a[0:3], a[168:171], v[164:167]
v_mfma_f32_16x16x32_bf16 v[168:171], a[4:7], a[168:171], v[168:171]
v_mfma_f32_16x16x32_bf16 v[172:175], a[8:11], a[168:171], v[172:175]
ds_read_b128 a[192:195], v23 offset:46768
v_mfma_f32_16x16x32_bf16 v[164:167], a[12:15], a[172:175], v[164:167]
v_fma_f32 v238, v152, 0.5, v68
v_fma_f32 v239, v153, 0.5, v69
v_mfma_f32_16x16x32_bf16 v[168:171], a[16:19], a[172:175], v[168:171]
v_cvt_pk_bf16_f32 v232, v238, v239
v_mfma_f32_16x16x32_bf16 v[172:175], a[20:23], a[172:175], v[172:175]
ds_read_b128 a[196:199], v23 offset:46832
s_waitcnt lgkmcnt(4)
v_mfma_f32_16x16x32_bf16 v[164:167], a[24:27], a[176:179], v[164:167]
v_fma_f32 v240, v154, 0.5, v70
v_mfma_f32_16x16x32_bf16 v[168:171], a[28:31], a[176:179], v[168:171]
v_fma_f32 v241, v155, 0.5, v71
v_cvt_pk_bf16_f32 v233, v240, v241
v_mfma_f32_16x16x32_bf16 v[172:175], a[32:35], a[176:179], v[172:175]
ds_read_b128 a[168:171], v23 offset:46896
v_mfma_f32_16x16x32_bf16 v[164:167], a[36:39], a[180:183], v[164:167]
v_fma_f32 v238, v156, 0.5, v72
v_mfma_f32_16x16x32_bf16 v[168:171], a[40:43], a[180:183], v[168:171]
v_fma_f32 v239, v157, 0.5, v73
v_mfma_f32_16x16x32_bf16 v[172:175], a[44:47], a[180:183], v[172:175]
ds_read_b128 a[172:175], v23 offset:46960
s_waitcnt lgkmcnt(4)
v_mfma_f32_16x16x32_bf16 v[164:167], a[48:51], a[184:187], v[164:167]
v_cvt_pk_bf16_f32 v234, v238, v239
v_mfma_f32_16x16x32_bf16 v[168:171], a[52:55], a[184:187], v[168:171]
v_fma_f32 v240, v158, 0.5, v74
v_fma_f32 v241, v159, 0.5, v75
v_mfma_f32_16x16x32_bf16 v[172:175], a[56:59], a[184:187], v[172:175]
ds_read_b128 a[176:179], v23 offset:47024
v_mfma_f32_16x16x32_bf16 v[164:167], a[60:63], a[188:191], v[164:167]
v_cvt_pk_bf16_f32 v235, v240, v241
v_mfma_f32_16x16x32_bf16 v[168:171], a[64:67], a[188:191], v[168:171]
v_fma_f32 v238, v160, 0.5, v76
v_mfma_f32_16x16x32_bf16 v[172:175], a[68:71], a[188:191], v[172:175]
ds_read_b128 a[180:183], v23 offset:47088
s_waitcnt lgkmcnt(4)
v_mfma_f32_16x16x32_bf16 v[164:167], a[72:75], a[192:195], v[164:167]
v_fma_f32 v239, v161, 0.5, v77
v_cvt_pk_bf16_f32 v236, v238, v239
v_mfma_f32_16x16x32_bf16 v[168:171], a[76:79], a[192:195], v[168:171]
v_fma_f32 v240, v162, 0.5, v78
v_mfma_f32_16x16x32_bf16 v[172:175], a[80:83], a[192:195], v[172:175]
ds_read_b128 a[184:187], v23 offset:47168
v_mfma_f32_16x16x32_bf16 v[164:167], a[84:87], a[196:199], v[164:167]
v_fma_f32 v241, v163, 0.5, v79
v_mfma_f32_16x16x32_bf16 v[168:171], a[88:91], a[196:199], v[168:171]
v_cvt_pk_bf16_f32 v237, v240, v241
v_mfma_f32_16x16x32_bf16 v[172:175], a[92:95], a[196:199], v[172:175]
ds_read_b128 a[188:191], v23 offset:47232
s_waitcnt lgkmcnt(4)
v_mfma_f32_16x16x32_bf16 v[164:167], a[96:99], a[168:171], v[164:167]
buffer_store_dwordx4 v[232:235], v203, s[36:39], s56 offen
v_add_u32 v9, v203, v30
v_mfma_f32_16x16x32_bf16 v[168:171], a[100:103], a[168:171], v[168:171]
buffer_store_dwordx2 v[236:237], v9, s[36:39], s56 offen
v_mfma_f32_16x16x32_bf16 v[172:175], a[104:107], a[168:171], v[172:175]
ds_read_b128 a[192:195], v23 offset:47296
v_mfma_f32_16x16x32_bf16 v[164:167], a[108:111], a[172:175], v[164:167]
v_fma_f32 v250, v152, -0.5, v68
v_mfma_f32_16x16x32_bf16 v[168:171], a[112:115], a[172:175], v[168:171]
v_fma_f32 v251, v153, -0.5, v69
v_cvt_pk_bf16_f32 v244, v250, v251
v_mfma_f32_16x16x32_bf16 v[172:175], a[116:119], a[172:175], v[172:175]
ds_read_b128 a[196:199], v23 offset:47360
s_waitcnt lgkmcnt(4)
v_mfma_f32_16x16x32_bf16 v[164:167], a[120:123], a[176:179], v[164:167]
v_fma_f32 v252, v154, -0.5, v70
v_mfma_f32_16x16x32_bf16 v[168:171], a[156:159], a[176:179], v[168:171]
v_fma_f32 v253, v155, -0.5, v71
v_mfma_f32_16x16x32_bf16 v[172:175], a[160:163], a[176:179], v[172:175]
ds_read_b128 a[168:171], v23 offset:47424
v_mfma_f32_16x16x32_bf16 v[164:167], a[164:167], a[180:183], v[164:167]
v_cvt_pk_bf16_f32 v245, v252, v253
v_mfma_f32_16x16x32_bf16 v[168:171], a[248:251], a[180:183], v[168:171]
v_fma_f32 v250, v156, -0.5, v72
v_fma_f32 v251, v157, -0.5, v73
v_mfma_f32_16x16x32_bf16 v[172:175], a[252:255], a[180:183], v[172:175]
ds_read_b128 a[172:175], v23 offset:47488
s_waitcnt lgkmcnt(4)
v_mfma_f32_16x16x32_bf16 v[164:167], a[200:203], a[184:187], v[164:167]
v_cvt_pk_bf16_f32 v246, v250, v251
v_mfma_f32_16x16x32_bf16 v[168:171], a[204:207], a[184:187], v[168:171]
v_fma_f32 v252, v158, -0.5, v74
v_mfma_f32_16x16x32_bf16 v[172:175], a[208:211], a[184:187], v[172:175]
ds_read_b128 a[176:179], v24 offset:46368
v_mfma_f32_16x16x32_bf16 v[164:167], a[212:215], a[188:191], v[164:167]
v_fma_f32 v253, v159, -0.5, v75
v_cvt_pk_bf16_f32 v247, v252, v253
v_mfma_f32_16x16x32_bf16 v[168:171], a[216:219], a[188:191], v[168:171]
v_fma_f32 v250, v160, -0.5, v76
v_mfma_f32_16x16x32_bf16 v[172:175], a[220:223], a[188:191], v[172:175]
ds_read_b128 a[180:183], v24 offset:46432
s_waitcnt lgkmcnt(4)
v_mfma_f32_16x16x32_bf16 v[164:167], a[224:227], a[192:195], v[164:167]
v_fma_f32 v251, v161, -0.5, v77
v_mfma_f32_16x16x32_bf16 v[168:171], a[228:231], a[192:195], v[168:171]
v_cvt_pk_bf16_f32 v248, v250, v251
v_mfma_f32_16x16x32_bf16 v[172:175], a[232:235], a[192:195], v[172:175]
ds_read_b128 a[184:187], v24 offset:46496
v_mfma_f32_16x16x32_bf16 v[164:167], a[236:239], a[196:199], v[164:167]
v_fma_f32 v252, v162, -0.5, v78
v_fma_f32 v253, v163, -0.5, v79
v_mfma_f32_16x16x32_bf16 v[168:171], a[240:243], a[196:199], v[168:171]
v_cvt_pk_bf16_f32 v249, v252, v253
v_mfma_f32_16x16x32_bf16 v[172:175], a[244:247], a[196:199], v[172:175]
ds_read_b128 a[188:191], v24 offset:46560
s_waitcnt lgkmcnt(4)
v_mfma_f32_16x16x32_bf16 v[164:167], a[128:131], a[168:171], v[164:167]
buffer_store_dwordx4 v[244:247], v203, s[36:39], s57 offen
v_mfma_f32_16x16x32_bf16 v[168:171], a[132:135], a[168:171], v[168:171]
buffer_store_dwordx2 v[248:249], v9, s[36:39], s57 offen
v_mfma_f32_16x16x32_bf16 v[172:175], a[136:139], a[168:171], v[172:175]
ds_read_b128 a[192:195], v24 offset:46624
v_mfma_f32_16x16x32_bf16 v[164:167], a[140:143], a[172:175], v[164:167]
v_mfma_f32_16x16x32_bf16 v[168:171], a[144:147], a[172:175], v[168:171]
v_mfma_f32_16x16x32_bf16 v[172:175], a[148:151], a[172:175], v[172:175]
ds_read_b128 a[196:199], v24 offset:46688
s_waitcnt lgkmcnt(4)
v_mfma_f32_16x16x32_bf16 v[176:179], a[0:3], a[176:179], v[176:179]
v_mfma_f32_16x16x32_bf16 v[180:183], a[4:7], a[176:179], v[180:183]
v_mfma_f32_16x16x32_bf16 v[184:187], a[8:11], a[176:179], v[184:187]
ds_read_b128 a[168:171], v24 offset:46768
v_mfma_f32_16x16x32_bf16 v[176:179], a[12:15], a[180:183], v[176:179]
v_fma_f32 v214, v164, 0.5, v80
v_fma_f32 v215, v165, 0.5, v81
v_mfma_f32_16x16x32_bf16 v[180:183], a[16:19], a[180:183], v[180:183]
v_cvt_pk_bf16_f32 v208, v214, v215
v_mfma_f32_16x16x32_bf16 v[184:187], a[20:23], a[180:183], v[184:187]
ds_read_b128 a[172:175], v24 offset:46832
s_waitcnt lgkmcnt(4)
v_mfma_f32_16x16x32_bf16 v[176:179], a[24:27], a[184:187], v[176:179]
v_fma_f32 v216, v166, 0.5, v82
v_mfma_f32_16x16x32_bf16 v[180:183], a[28:31], a[184:187], v[180:183]
v_fma_f32 v217, v167, 0.5, v83
v_cvt_pk_bf16_f32 v209, v216, v217
v_mfma_f32_16x16x32_bf16 v[184:187], a[32:35], a[184:187], v[184:187]
ds_read_b128 a[176:179], v24 offset:46896
v_mfma_f32_16x16x32_bf16 v[176:179], a[36:39], a[188:191], v[176:179]
v_fma_f32 v214, v168, 0.5, v84
v_mfma_f32_16x16x32_bf16 v[180:183], a[40:43], a[188:191], v[180:183]
v_fma_f32 v215, v169, 0.5, v85
v_mfma_f32_16x16x32_bf16 v[184:187], a[44:47], a[188:191], v[184:187]
ds_read_b128 a[180:183], v24 offset:46960
s_waitcnt lgkmcnt(4)
v_mfma_f32_16x16x32_bf16 v[176:179], a[48:51], a[192:195], v[176:179]
v_cvt_pk_bf16_f32 v210, v214, v215
v_mfma_f32_16x16x32_bf16 v[180:183], a[52:55], a[192:195], v[180:183]
v_fma_f32 v216, v170, 0.5, v86
v_fma_f32 v217, v171, 0.5, v87
v_mfma_f32_16x16x32_bf16 v[184:187], a[56:59], a[192:195], v[184:187]
ds_read_b128 a[184:187], v24 offset:47024
v_mfma_f32_16x16x32_bf16 v[176:179], a[60:63], a[196:199], v[176:179]
v_cvt_pk_bf16_f32 v211, v216, v217
v_mfma_f32_16x16x32_bf16 v[180:183], a[64:67], a[196:199], v[180:183]
v_fma_f32 v214, v172, 0.5, v88
v_mfma_f32_16x16x32_bf16 v[184:187], a[68:71], a[196:199], v[184:187]
ds_read_b128 a[188:191], v24 offset:47088
s_waitcnt lgkmcnt(4)
v_mfma_f32_16x16x32_bf16 v[176:179], a[72:75], a[168:171], v[176:179]
v_fma_f32 v215, v173, 0.5, v89
v_cvt_pk_bf16_f32 v212, v214, v215
v_mfma_f32_16x16x32_bf16 v[180:183], a[76:79], a[168:171], v[180:183]
v_fma_f32 v216, v174, 0.5, v90
v_mfma_f32_16x16x32_bf16 v[184:187], a[80:83], a[168:171], v[184:187]
ds_read_b128 a[192:195], v24 offset:47168
v_mfma_f32_16x16x32_bf16 v[176:179], a[84:87], a[172:175], v[176:179]
v_fma_f32 v217, v175, 0.5, v91
v_mfma_f32_16x16x32_bf16 v[180:183], a[88:91], a[172:175], v[180:183]
v_cvt_pk_bf16_f32 v213, v216, v217
v_mfma_f32_16x16x32_bf16 v[184:187], a[92:95], a[172:175], v[184:187]
ds_read_b128 a[196:199], v24 offset:47232
s_waitcnt lgkmcnt(4)
v_mfma_f32_16x16x32_bf16 v[176:179], a[96:99], a[176:179], v[176:179]
buffer_store_dwordx4 v[208:211], v204, s[36:39], s56 offen
v_add_u32 v10, v204, v30
v_mfma_f32_16x16x32_bf16 v[180:183], a[100:103], a[176:179], v[180:183]
buffer_store_dwordx2 v[212:213], v10, s[36:39], s56 offen
v_mfma_f32_16x16x32_bf16 v[184:187], a[104:107], a[176:179], v[184:187]
ds_read_b128 a[168:171], v24 offset:47296
v_mfma_f32_16x16x32_bf16 v[176:179], a[108:111], a[180:183], v[176:179]
v_fma_f32 v226, v164, -0.5, v80
v_mfma_f32_16x16x32_bf16 v[180:183], a[112:115], a[180:183], v[180:183]
v_fma_f32 v227, v165, -0.5, v81
v_cvt_pk_bf16_f32 v220, v226, v227
v_mfma_f32_16x16x32_bf16 v[184:187], a[116:119], a[180:183], v[184:187]
ds_read_b128 a[172:175], v24 offset:47360
s_waitcnt lgkmcnt(4)
v_mfma_f32_16x16x32_bf16 v[176:179], a[120:123], a[184:187], v[176:179]
v_fma_f32 v228, v166, -0.5, v82
v_mfma_f32_16x16x32_bf16 v[180:183], a[156:159], a[184:187], v[180:183]
v_fma_f32 v229, v167, -0.5, v83
v_mfma_f32_16x16x32_bf16 v[184:187], a[160:163], a[184:187], v[184:187]
ds_read_b128 a[176:179], v24 offset:47424
v_mfma_f32_16x16x32_bf16 v[176:179], a[164:167], a[188:191], v[176:179]
v_cvt_pk_bf16_f32 v221, v228, v229
v_mfma_f32_16x16x32_bf16 v[180:183], a[248:251], a[188:191], v[180:183]
v_fma_f32 v226, v168, -0.5, v84
v_fma_f32 v227, v169, -0.5, v85
v_mfma_f32_16x16x32_bf16 v[184:187], a[252:255], a[188:191], v[184:187]
ds_read_b128 a[180:183], v24 offset:47488
s_waitcnt lgkmcnt(4)
v_mfma_f32_16x16x32_bf16 v[176:179], a[200:203], a[192:195], v[176:179]
v_cvt_pk_bf16_f32 v222, v226, v227
v_mfma_f32_16x16x32_bf16 v[180:183], a[204:207], a[192:195], v[180:183]
v_fma_f32 v228, v170, -0.5, v86
v_mfma_f32_16x16x32_bf16 v[184:187], a[208:211], a[192:195], v[184:187]
ds_read_b128 a[184:187], v2 offset:46368
v_mfma_f32_16x16x32_bf16 v[176:179], a[212:215], a[196:199], v[176:179]
v_fma_f32 v229, v171, -0.5, v87
v_cvt_pk_bf16_f32 v223, v228, v229
v_mfma_f32_16x16x32_bf16 v[180:183], a[216:219], a[196:199], v[180:183]
v_fma_f32 v226, v172, -0.5, v88
v_mfma_f32_16x16x32_bf16 v[184:187], a[220:223], a[196:199], v[184:187]
ds_read_b128 a[188:191], v2 offset:46432
s_waitcnt lgkmcnt(4)
v_mfma_f32_16x16x32_bf16 v[176:179], a[224:227], a[168:171], v[176:179]
v_fma_f32 v227, v173, -0.5, v89
v_mfma_f32_16x16x32_bf16 v[180:183], a[228:231], a[168:171], v[180:183]
v_cvt_pk_bf16_f32 v224, v226, v227
v_mfma_f32_16x16x32_bf16 v[184:187], a[232:235], a[168:171], v[184:187]
ds_read_b128 a[192:195], v2 offset:46496
v_mfma_f32_16x16x32_bf16 v[176:179], a[236:239], a[172:175], v[176:179]
v_fma_f32 v228, v174, -0.5, v90
v_fma_f32 v229, v175, -0.5, v91
v_mfma_f32_16x16x32_bf16 v[180:183], a[240:243], a[172:175], v[180:183]
v_cvt_pk_bf16_f32 v225, v228, v229
v_mfma_f32_16x16x32_bf16 v[184:187], a[244:247], a[172:175], v[184:187]
ds_read_b128 a[196:199], v2 offset:46560
s_waitcnt lgkmcnt(4)
v_mfma_f32_16x16x32_bf16 v[176:179], a[128:131], a[176:179], v[176:179]
buffer_store_dwordx4 v[220:223], v204, s[36:39], s57 offen
v_mfma_f32_16x16x32_bf16 v[180:183], a[132:135], a[176:179], v[180:183]
buffer_store_dwordx2 v[224:225], v10, s[36:39], s57 offen
v_mfma_f32_16x16x32_bf16 v[184:187], a[136:139], a[176:179], v[184:187]
ds_read_b128 a[168:171], v2 offset:46624
v_mfma_f32_16x16x32_bf16 v[176:179], a[140:143], a[180:183], v[176:179]
v_mfma_f32_16x16x32_bf16 v[180:183], a[144:147], a[180:183], v[180:183]
v_mfma_f32_16x16x32_bf16 v[184:187], a[148:151], a[180:183], v[184:187]
ds_read_b128 a[172:175], v2 offset:46688
s_waitcnt lgkmcnt(4)
v_mfma_f32_16x16x32_bf16 v[188:191], a[0:3], a[184:187], v[188:191]
v_mfma_f32_16x16x32_bf16 v[192:195], a[4:7], a[184:187], v[192:195]
v_mfma_f32_16x16x32_bf16 v[196:199], a[8:11], a[184:187], v[196:199]
ds_read_b128 a[176:179], v2 offset:46768
v_mfma_f32_16x16x32_bf16 v[188:191], a[12:15], a[188:191], v[188:191]
v_fma_f32 v238, v176, 0.5, v92
v_fma_f32 v239, v177, 0.5, v93
v_mfma_f32_16x16x32_bf16 v[192:195], a[16:19], a[188:191], v[192:195]
v_cvt_pk_bf16_f32 v232, v238, v239
v_mfma_f32_16x16x32_bf16 v[196:199], a[20:23], a[188:191], v[196:199]
ds_read_b128 a[180:183], v2 offset:46832
s_waitcnt lgkmcnt(4)
v_mfma_f32_16x16x32_bf16 v[188:191], a[24:27], a[192:195], v[188:191]
v_fma_f32 v240, v178, 0.5, v94
v_mfma_f32_16x16x32_bf16 v[192:195], a[28:31], a[192:195], v[192:195]
v_fma_f32 v241, v179, 0.5, v95
v_cvt_pk_bf16_f32 v233, v240, v241
v_mfma_f32_16x16x32_bf16 v[196:199], a[32:35], a[192:195], v[196:199]
ds_read_b128 a[184:187], v2 offset:46896
v_mfma_f32_16x16x32_bf16 v[188:191], a[36:39], a[196:199], v[188:191]
v_fma_f32 v238, v180, 0.5, v96
v_mfma_f32_16x16x32_bf16 v[192:195], a[40:43], a[196:199], v[192:195]
v_fma_f32 v239, v181, 0.5, v97
v_mfma_f32_16x16x32_bf16 v[196:199], a[44:47], a[196:199], v[196:199]
ds_read_b128 a[188:191], v2 offset:46960
s_waitcnt lgkmcnt(4)
v_mfma_f32_16x16x32_bf16 v[188:191], a[48:51], a[168:171], v[188:191]
v_cvt_pk_bf16_f32 v234, v238, v239
v_mfma_f32_16x16x32_bf16 v[192:195], a[52:55], a[168:171], v[192:195]
v_fma_f32 v240, v182, 0.5, v98
v_fma_f32 v241, v183, 0.5, v99
v_mfma_f32_16x16x32_bf16 v[196:199], a[56:59], a[168:171], v[196:199]
ds_read_b128 a[192:195], v2 offset:47024
v_mfma_f32_16x16x32_bf16 v[188:191], a[60:63], a[172:175], v[188:191]
v_cvt_pk_bf16_f32 v235, v240, v241
v_mfma_f32_16x16x32_bf16 v[192:195], a[64:67], a[172:175], v[192:195]
v_fma_f32 v238, v184, 0.5, v100
v_mfma_f32_16x16x32_bf16 v[196:199], a[68:71], a[172:175], v[196:199]
ds_read_b128 a[196:199], v2 offset:47088
s_waitcnt lgkmcnt(4)
v_mfma_f32_16x16x32_bf16 v[188:191], a[72:75], a[176:179], v[188:191]
v_fma_f32 v239, v185, 0.5, v101
v_cvt_pk_bf16_f32 v236, v238, v239
v_mfma_f32_16x16x32_bf16 v[192:195], a[76:79], a[176:179], v[192:195]
v_fma_f32 v240, v186, 0.5, v102
v_mfma_f32_16x16x32_bf16 v[196:199], a[80:83], a[176:179], v[196:199]
ds_read_b128 a[168:171], v2 offset:47168
v_mfma_f32_16x16x32_bf16 v[188:191], a[84:87], a[180:183], v[188:191]
v_fma_f32 v241, v187, 0.5, v103
v_mfma_f32_16x16x32_bf16 v[192:195], a[88:91], a[180:183], v[192:195]
v_cvt_pk_bf16_f32 v237, v240, v241
v_mfma_f32_16x16x32_bf16 v[196:199], a[92:95], a[180:183], v[196:199]
ds_read_b128 a[172:175], v2 offset:47232
s_waitcnt lgkmcnt(4)
v_mfma_f32_16x16x32_bf16 v[188:191], a[96:99], a[184:187], v[188:191]
buffer_store_dwordx4 v[232:235], v205, s[36:39], s56 offen
v_add_u32 v11, v205, v30
v_mfma_f32_16x16x32_bf16 v[192:195], a[100:103], a[184:187], v[192:195]
buffer_store_dwordx2 v[236:237], v11, s[36:39], s56 offen
v_mfma_f32_16x16x32_bf16 v[196:199], a[104:107], a[184:187], v[196:199]
ds_read_b128 a[176:179], v2 offset:47296
v_mfma_f32_16x16x32_bf16 v[188:191], a[108:111], a[188:191], v[188:191]
v_fma_f32 v250, v176, -0.5, v92
v_mfma_f32_16x16x32_bf16 v[192:195], a[112:115], a[188:191], v[192:195]
v_fma_f32 v251, v177, -0.5, v93
v_cvt_pk_bf16_f32 v244, v250, v251
v_mfma_f32_16x16x32_bf16 v[196:199], a[116:119], a[188:191], v[196:199]
ds_read_b128 a[180:183], v2 offset:47360
s_waitcnt lgkmcnt(4)
v_mfma_f32_16x16x32_bf16 v[188:191], a[120:123], a[192:195], v[188:191]
v_fma_f32 v252, v178, -0.5, v94
v_mfma_f32_16x16x32_bf16 v[192:195], a[156:159], a[192:195], v[192:195]
v_fma_f32 v253, v179, -0.5, v95
v_mfma_f32_16x16x32_bf16 v[196:199], a[160:163], a[192:195], v[196:199]
ds_read_b128 a[184:187], v2 offset:47424
v_mfma_f32_16x16x32_bf16 v[188:191], a[164:167], a[196:199], v[188:191]
v_cvt_pk_bf16_f32 v245, v252, v253
v_mfma_f32_16x16x32_bf16 v[192:195], a[248:251], a[196:199], v[192:195]
v_fma_f32 v250, v180, -0.5, v96
v_fma_f32 v251, v181, -0.5, v97
v_mfma_f32_16x16x32_bf16 v[196:199], a[252:255], a[196:199], v[196:199]
ds_read_b128 a[188:191], v2 offset:47488
s_waitcnt lgkmcnt(4)
v_mfma_f32_16x16x32_bf16 v[188:191], a[200:203], a[168:171], v[188:191]
v_cvt_pk_bf16_f32 v246, v250, v251
v_mfma_f32_16x16x32_bf16 v[192:195], a[204:207], a[168:171], v[192:195]
v_fma_f32 v252, v182, -0.5, v98
v_mfma_f32_16x16x32_bf16 v[196:199], a[208:211], a[168:171], v[196:199]
v_mfma_f32_16x16x32_bf16 v[188:191], a[212:215], a[172:175], v[188:191]
v_fma_f32 v253, v183, -0.5, v99
v_cvt_pk_bf16_f32 v247, v252, v253
v_mfma_f32_16x16x32_bf16 v[192:195], a[216:219], a[172:175], v[192:195]
v_fma_f32 v250, v184, -0.5, v100
v_mfma_f32_16x16x32_bf16 v[196:199], a[220:223], a[172:175], v[196:199]
s_waitcnt lgkmcnt(2)
v_mfma_f32_16x16x32_bf16 v[188:191], a[224:227], a[176:179], v[188:191]
v_fma_f32 v251, v185, -0.5, v101
v_mfma_f32_16x16x32_bf16 v[192:195], a[228:231], a[176:179], v[192:195]
v_cvt_pk_bf16_f32 v248, v250, v251
v_mfma_f32_16x16x32_bf16 v[196:199], a[232:235], a[176:179], v[196:199]
v_mfma_f32_16x16x32_bf16 v[188:191], a[236:239], a[180:183], v[188:191]
v_fma_f32 v252, v186, -0.5, v102
v_fma_f32 v253, v187, -0.5, v103
v_mfma_f32_16x16x32_bf16 v[192:195], a[240:243], a[180:183], v[192:195]
v_cvt_pk_bf16_f32 v249, v252, v253
v_mfma_f32_16x16x32_bf16 v[196:199], a[244:247], a[180:183], v[196:199]
s_waitcnt lgkmcnt(0)
v_mfma_f32_16x16x32_bf16 v[188:191], a[128:131], a[184:187], v[188:191]
buffer_store_dwordx4 v[244:247], v205, s[36:39], s57 offen
v_mfma_f32_16x16x32_bf16 v[192:195], a[132:135], a[184:187], v[192:195]
buffer_store_dwordx2 v[248:249], v11, s[36:39], s57 offen
v_mfma_f32_16x16x32_bf16 v[196:199], a[136:139], a[184:187], v[196:199]
v_mfma_f32_16x16x32_bf16 v[188:191], a[140:143], a[188:191], v[188:191]
v_mfma_f32_16x16x32_bf16 v[192:195], a[144:147], a[188:191], v[192:195]
v_mfma_f32_16x16x32_bf16 v[196:199], a[148:151], a[188:191], v[196:199]
s_nop 5
v_fma_f32 v214, v188, 0.5, v104
v_fma_f32 v215, v189, 0.5, v105
v_cvt_pk_bf16_f32 v208, v214, v215
v_fma_f32 v216, v190, 0.5, v106
v_fma_f32 v217, v191, 0.5, v107
v_cvt_pk_bf16_f32 v209, v216, v217
v_fma_f32 v214, v192, 0.5, v108
v_fma_f32 v215, v193, 0.5, v109
v_cvt_pk_bf16_f32 v210, v214, v215
v_fma_f32 v216, v194, 0.5, v110
v_fma_f32 v217, v195, 0.5, v111
v_cvt_pk_bf16_f32 v211, v216, v217
v_fma_f32 v214, v196, 0.5, v112
v_fma_f32 v215, v197, 0.5, v113
v_cvt_pk_bf16_f32 v212, v214, v215
v_fma_f32 v216, v198, 0.5, v114
v_fma_f32 v217, v199, 0.5, v115
v_cvt_pk_bf16_f32 v213, v216, v217
buffer_store_dwordx4 v[208:211], v206, s[36:39], s56 offen
v_add_u32 v12, v206, v30
buffer_store_dwordx2 v[212:213], v12, s[36:39], s56 offen
v_fma_f32 v226, v188, -0.5, v104
v_fma_f32 v227, v189, -0.5, v105
v_cvt_pk_bf16_f32 v220, v226, v227
v_fma_f32 v228, v190, -0.5, v106
v_fma_f32 v229, v191, -0.5, v107
v_cvt_pk_bf16_f32 v221, v228, v229
v_fma_f32 v226, v192, -0.5, v108
v_fma_f32 v227, v193, -0.5, v109
v_cvt_pk_bf16_f32 v222, v226, v227
v_fma_f32 v228, v194, -0.5, v110
v_fma_f32 v229, v195, -0.5, v111
v_cvt_pk_bf16_f32 v223, v228, v229
v_fma_f32 v226, v196, -0.5, v112
v_fma_f32 v227, v197, -0.5, v113
v_cvt_pk_bf16_f32 v224, v226, v227
v_fma_f32 v228, v198, -0.5, v114
v_fma_f32 v229, v199, -0.5, v115
v_cvt_pk_bf16_f32 v225, v228, v229
buffer_store_dwordx4 v[220:223], v206, s[36:39], s57 offen
buffer_store_dwordx2 v[224:225], v12, s[36:39], s57 offen
Lend:
s_endpgm
.section .rodata,"a"
.p2align 6
.amdhsa_kernel standalone__detection_seg_fpn_lateral__vision_kernel
  .amdhsa_next_free_vgpr 512
  .amdhsa_next_free_sgpr 102
  .amdhsa_accum_offset 256
  .amdhsa_group_segment_fixed_size 0
  .amdhsa_kernarg_size 56
  .amdhsa_user_sgpr_count 2
  .amdhsa_user_sgpr_kernarg_segment_ptr 1
  .amdhsa_system_sgpr_workgroup_id_x 1
.end_amdhsa_kernel
```
